```python
import torch

def _softmax(x, axis=-1):
    return torch.softmax(x, dim=axis)
def _gelu(x):
    return torch.nn.functional.gelu(x, approximate="tanh")
def _silu(x):
    return torch.nn.functional.silu(x)
def _sigmoid(x):
    return torch.sigmoid(x)
def _layernorm(x, axis=-1, eps=1e-5):
    m = x.mean(dim=axis, keepdim=True)
    v = x.var(dim=axis, keepdim=True, unbiased=False)
    return (x - m) / torch.sqrt(v + eps)
def _scatter_add(tgt, idx, src, axis=0):
    return tgt.clone().index_add_(axis, idx, src)
def _segment_sum(src, seg, n):
    out = torch.zeros((n,) + src.shape[1:], dtype=src.dtype)
    return out.index_add_(0, seg, src)
def _pad(x, pw):
    flat = tuple(v for pair in reversed(pw) for v in pair)
    return torch.nn.functional.pad(x, flat)

kernel_name = 'sequential_preLN__linear_kernel_hedgehog__glu_gated_glu__prompt'

def setup_inputs():

    _w = (lambda a: (lambda t: t.to(torch.bfloat16) if t.is_floating_point() else t)(torch.as_tensor(a)))
    def _A_setup():
        B, S, D, H = 1, 2048, 512, 32
        Dh = D // H
        return {
            "x": _w((lambda *s: torch.randn(*s, dtype=torch.bfloat16) * 0.05)(B, S, D)),
            "wqkv": _w((lambda *s: torch.randn(*s, dtype=torch.bfloat16) * 0.2)(D, 3 * D)),
            "w_phi": _w((lambda *s: torch.randn(*s, dtype=torch.bfloat16) * 0.2)(H, Dh, Dh) * (Dh ** -0.5)),
            "wo": _w((lambda *s: torch.randn(*s, dtype=torch.bfloat16) * 0.05)(D, D)),
        }
    _A_in = _A_setup()

    def _B_setup():
        B, S, D, F = 1, 2048, 512, 1792
        return {
            "x": _w((lambda *s: torch.randn(*s, dtype=torch.bfloat16) * 0.05)(B, S, D)),
            "w_gate": _w((lambda *s: torch.randn(*s, dtype=torch.bfloat16) * 0.05)(D, F)),
            "w_up": _w((lambda *s: torch.randn(*s, dtype=torch.bfloat16) * 0.05)(D, F)),
            "w_down": _w((lambda *s: torch.randn(*s, dtype=torch.bfloat16) * 0.05)(F, D)),
        }
    _B_in = _B_setup()

    return {
        "A_x": _A_in["x"],
        "A_wqkv": _A_in["wqkv"],
        "A_w_phi": _A_in["w_phi"],
        "A_wo": _A_in["wo"],
        "B_x": _B_in["x"],
        "B_w_gate": _B_in["w_gate"],
        "B_w_up": _B_in["w_up"],
        "B_w_down": _B_in["w_down"],
    }

def reference(A_x, A_wqkv, A_w_phi, A_wo, B_x, B_w_gate, B_w_up, B_w_down):
    def _A_ref(x, wqkv, w_phi, wo):
        B, S, D = x.shape
        H = 32; Dh = D // H
        qkv = (lambda x, *d: x.permute(*d))((x @ wqkv).reshape(B, S, 3, H, Dh), 2, 0, 3, 1, 4)
        q, k, v = qkv[0], qkv[1], qkv[2]
        pq = torch.einsum("bhsd,hdf->bhsf", q, w_phi)
        pk = torch.einsum("bhsd,hdf->bhsf", k, w_phi)
        phi_q = torch.concatenate([_softmax(pq, axis=-1), _softmax(-pq, axis=-1)], axis=-1)
        phi_k = torch.concatenate([_softmax(pk, axis=-1), _softmax(-pk, axis=-1)], axis=-1)
        kv = torch.einsum("bhsf,bhsd->bhfd", phi_k, v)
        z  = torch.einsum("bhsf->bhf", phi_k)
        num = torch.einsum("bhqf,bhfd->bhqd", phi_q, kv)
        den = torch.einsum("bhqf,bhf->bhq", phi_q, z)[..., None] + 1e-6
        o = num / den
        return (lambda x, *d: x.permute(*d))(o, 0, 2, 1, 3).reshape(B, S, D) @ wo

    def _B_ref(x, w_gate, w_up, w_down):
        g = torch.einsum("bsd,df->bsf", x, w_gate)
        u = torch.einsum("bsd,df->bsf", x, w_up)
        h = _sigmoid(g) * u
        return torch.einsum("bsf,fd->bsd", h, w_down)

    x = A_x
    h = x + _A_ref(_layernorm(x, axis=-1), A_wqkv, A_w_phi, A_wo)
    h2 = h + _B_ref(_layernorm(h, axis=-1), B_w_gate, B_w_up, B_w_down)
    return h2
```

```asm
; @launch grid=(256,1,1) block=(256,1,1) lds=163840
.amdgcn_target "amdgcn-amd-amdhsa--gfx950"
.text
.globl sequential_preLN__linear_kernel_hedgehog__glu_gated_glu__prompt_kernel
.p2align 8
.type sequential_preLN__linear_kernel_hedgehog__glu_gated_glu__prompt_kernel,@function
sequential_preLN__linear_kernel_hedgehog__glu_gated_glu__prompt_kernel:
 s_getpc_b64 s[62:63]
 s_cmp_ge_u32 s2, 256
 s_cbranch_scc1 L_end
 s_load_dwordx16 s[64:79], s[0:1], 0
 s_load_dwordx4 s[80:83], s[0:1], 64
 s_load_dwordx2 s[84:85], s[0:1], 80
 v_and_b32 v1, 63, v0
 v_lshrrev_b32 v2, 6, v0
 s_nop 0
 v_readfirstlane_b32 s20, v2
 s_and_b32 s21, s2, 7
 s_lshr_b32 s22, s2, 3
 s_lshr_b32 s24, s21, 1
 s_lshl_b32 s24, s24, 2
 s_lshr_b32 s23, s22, 3
 s_add_u32 s24, s24, s23
 s_and_b32 s25, s21, 1
 s_lshl_b32 s25, s25, 3
 s_and_b32 s23, s22, 7
 s_add_u32 s25, s25, s23
 s_lshl_b32 s26, s21, 2
 s_lshr_b32 s23, s22, 3
 s_add_u32 s26, s26, s23
 s_and_b32 s27, s22, 7
 s_lshr_b32 s28, s21, 2
 s_lshl_b32 s28, s28, 3
 s_lshr_b32 s23, s22, 2
 s_add_u32 s28, s28, s23
 s_and_b32 s29, s21, 3
 s_lshl_b32 s29, s29, 2
 s_and_b32 s23, s22, 3
 s_add_u32 s29, s29, s23
 s_lshr_b32 s30, s2, 4
 v_lshlrev_b32 v4, 4, v1
 s_cmp_ge_u32 s20, 2
 s_cbranch_scc1 DMAW1
 s_lshl_b32 s31, s2, 3
 s_lshl_b32 s32, s20, 2
 s_add_u32 s31, s31, s32
 s_lshl_b32 s32, s31, 10
 v_and_b32 v8, 3, v1
 v_lshrrev_b32 v9, 2, v1
 v_lshlrev_b32 v10, 10, v8
 v_lshlrev_b32 v11, 4, v9
 v_add_u32 v10, v10, v11
 s_waitcnt lgkmcnt(0)
 s_mov_b32 s8, s64
 s_and_b32 s9, s65, 0xffff
 s_mov_b32 s10, 0x200000
 s_mov_b32 s11, 0x20000
 s_mov_b32 s4, s84
 s_and_b32 s5, s85, 0xffff
 s_mov_b32 s6, 0x1900000
 s_mov_b32 s7, 0x20000
 s_and_b32 s35, s2, 15
 s_xor_b32 s37, s20, 1
 s_or_b32 s35, s35, s37
 s_cmp_lg_u32 s35, 0
 s_cbranch_scc1 Z3
 v_mov_b32 v28, 0
 v_mov_b32 v29, 0
 v_mov_b32 v30, 0
 v_mov_b32 v31, 0
 s_mul_i32 s35, s30, 4352
 s_add_u32 s35, s35, 0x400000
 buffer_store_dwordx4 v[28:31], v4, s[4:7], s35 offen offset:0 sc1
 buffer_store_dwordx4 v[28:31], v4, s[4:7], s35 offen offset:1024 sc1
 buffer_store_dwordx4 v[28:31], v4, s[4:7], s35 offen offset:2048 sc1
 buffer_store_dwordx4 v[28:31], v4, s[4:7], s35 offen offset:3072 sc1
 s_add_u32 s35, s35, 4096
 s_mov_b64 exec, 0xffff
 buffer_store_dwordx4 v[28:31], v4, s[4:7], s35 offen sc1
 s_lshl_b32 s35, s30, 9
 s_add_u32 s35, s35, 0xf90000
 s_mov_b32 exec_lo, -1
 buffer_store_dwordx4 v[28:31], v4, s[4:7], s35 offen sc1
 s_mov_b64 exec, -1
Z3:
 buffer_load_dwordx4 v[12:15], v10, s[8:11], s32 offen offset:0
 buffer_load_dwordx4 v[16:19], v10, s[8:11], s32 offen offset:256
 buffer_load_dwordx4 v[20:23], v10, s[8:11], s32 offen offset:512
 buffer_load_dwordx4 v[24:27], v10, s[8:11], s32 offen offset:768
 s_mov_b32 s59, 0xf30000
 s_load_dword s60, s[84:85], s59
 v_lshlrev_b32 v9, 7, v9
 v_lshlrev_b32 v8, 4, v8
 v_add_u32 v8, v8, v9
 s_lshl_b32 s36, s20, 6
 s_lshl_b32 s37, s2, 13
 s_add_u32 s36, s36, s37
 s_add_u32 s36, s36, 0x0
 s_waitcnt vmcnt(0)
 v_lshlrev_b32 v32, 16, v12
 v_and_b32 v33, 0xffff0000, v12
 v_lshlrev_b32 v34, 16, v13
 v_and_b32 v35, 0xffff0000, v13
 v_lshlrev_b32 v36, 16, v14
 v_and_b32 v37, 0xffff0000, v14
 v_lshlrev_b32 v38, 16, v15
 v_and_b32 v39, 0xffff0000, v15
 v_lshlrev_b32 v40, 16, v16
 v_and_b32 v41, 0xffff0000, v16
 v_lshlrev_b32 v42, 16, v17
 v_and_b32 v43, 0xffff0000, v17
 v_lshlrev_b32 v44, 16, v18
 v_and_b32 v45, 0xffff0000, v18
 v_lshlrev_b32 v46, 16, v19
 v_and_b32 v47, 0xffff0000, v19
 v_lshlrev_b32 v48, 16, v20
 v_and_b32 v49, 0xffff0000, v20
 v_lshlrev_b32 v50, 16, v21
 v_and_b32 v51, 0xffff0000, v21
 v_lshlrev_b32 v52, 16, v22
 v_and_b32 v53, 0xffff0000, v22
 v_lshlrev_b32 v54, 16, v23
 v_and_b32 v55, 0xffff0000, v23
 v_lshlrev_b32 v56, 16, v24
 v_and_b32 v57, 0xffff0000, v24
 v_lshlrev_b32 v58, 16, v25
 v_and_b32 v59, 0xffff0000, v25
 v_lshlrev_b32 v60, 16, v26
 v_and_b32 v61, 0xffff0000, v26
 v_lshlrev_b32 v62, 16, v27
 v_and_b32 v63, 0xffff0000, v27
 v_pk_add_f32 v[64:65], v[32:33], v[34:35]
 v_pk_add_f32 v[66:67], v[36:37], v[38:39]
 v_pk_add_f32 v[68:69], v[40:41], v[42:43]
 v_pk_add_f32 v[70:71], v[44:45], v[46:47]
 v_pk_add_f32 v[72:73], v[48:49], v[50:51]
 v_pk_add_f32 v[74:75], v[52:53], v[54:55]
 v_pk_add_f32 v[76:77], v[56:57], v[58:59]
 v_pk_add_f32 v[78:79], v[60:61], v[62:63]
 v_pk_add_f32 v[64:65], v[64:65], v[72:73]
 v_pk_add_f32 v[66:67], v[66:67], v[74:75]
 v_pk_add_f32 v[68:69], v[68:69], v[76:77]
 v_pk_add_f32 v[70:71], v[70:71], v[78:79]
 v_pk_add_f32 v[64:65], v[64:65], v[68:69]
 v_pk_add_f32 v[66:67], v[66:67], v[70:71]
 v_pk_add_f32 v[64:65], v[64:65], v[66:67]
 v_add_f32 v80, v64, v65
 s_nop 1
 v_add_f32_dpp v80, v80, v80 row_ror:4 row_mask:0xf bank_mask:0xf
 s_nop 1
 v_add_f32_dpp v80, v80, v80 row_ror:8 row_mask:0xf bank_mask:0xf
 v_mov_b32 v81, v80
 s_nop 1
 v_permlane16_swap_b32 v80, v81
 v_add_f32 v80, v80, v81
 v_mov_b32 v81, v80
 s_nop 1
 v_permlane32_swap_b32 v80, v81
 v_add_f32 v80, v80, v81
 v_mul_f32 v80, 0xbb000000, v80
 v_pk_add_f32 v[32:33], v[32:33], v[80:81] op_sel_hi:[1,0]
 v_pk_add_f32 v[34:35], v[34:35], v[80:81] op_sel_hi:[1,0]
 v_pk_add_f32 v[36:37], v[36:37], v[80:81] op_sel_hi:[1,0]
 v_pk_add_f32 v[38:39], v[38:39], v[80:81] op_sel_hi:[1,0]
 v_pk_add_f32 v[40:41], v[40:41], v[80:81] op_sel_hi:[1,0]
 v_pk_add_f32 v[42:43], v[42:43], v[80:81] op_sel_hi:[1,0]
 v_pk_add_f32 v[44:45], v[44:45], v[80:81] op_sel_hi:[1,0]
 v_pk_add_f32 v[46:47], v[46:47], v[80:81] op_sel_hi:[1,0]
 v_pk_add_f32 v[48:49], v[48:49], v[80:81] op_sel_hi:[1,0]
 v_pk_add_f32 v[50:51], v[50:51], v[80:81] op_sel_hi:[1,0]
 v_pk_add_f32 v[52:53], v[52:53], v[80:81] op_sel_hi:[1,0]
 v_pk_add_f32 v[54:55], v[54:55], v[80:81] op_sel_hi:[1,0]
 v_pk_add_f32 v[56:57], v[56:57], v[80:81] op_sel_hi:[1,0]
 v_pk_add_f32 v[58:59], v[58:59], v[80:81] op_sel_hi:[1,0]
 v_pk_add_f32 v[60:61], v[60:61], v[80:81] op_sel_hi:[1,0]
 v_pk_add_f32 v[62:63], v[62:63], v[80:81] op_sel_hi:[1,0]
 v_pk_mul_f32 v[64:65], v[32:33], v[32:33]
 v_pk_mul_f32 v[66:67], v[36:37], v[36:37]
 v_pk_mul_f32 v[68:69], v[40:41], v[40:41]
 v_pk_mul_f32 v[70:71], v[44:45], v[44:45]
 v_pk_mul_f32 v[72:73], v[48:49], v[48:49]
 v_pk_mul_f32 v[74:75], v[52:53], v[52:53]
 v_pk_mul_f32 v[76:77], v[56:57], v[56:57]
 v_pk_mul_f32 v[78:79], v[60:61], v[60:61]
 v_pk_fma_f32 v[64:65], v[34:35], v[34:35], v[64:65]
 v_pk_fma_f32 v[66:67], v[38:39], v[38:39], v[66:67]
 v_pk_fma_f32 v[68:69], v[42:43], v[42:43], v[68:69]
 v_pk_fma_f32 v[70:71], v[46:47], v[46:47], v[70:71]
 v_pk_fma_f32 v[72:73], v[50:51], v[50:51], v[72:73]
 v_pk_fma_f32 v[74:75], v[54:55], v[54:55], v[74:75]
 v_pk_fma_f32 v[76:77], v[58:59], v[58:59], v[76:77]
 v_pk_fma_f32 v[78:79], v[62:63], v[62:63], v[78:79]
 v_pk_add_f32 v[64:65], v[64:65], v[72:73]
 v_pk_add_f32 v[66:67], v[66:67], v[74:75]
 v_pk_add_f32 v[68:69], v[68:69], v[76:77]
 v_pk_add_f32 v[70:71], v[70:71], v[78:79]
 v_pk_add_f32 v[64:65], v[64:65], v[68:69]
 v_pk_add_f32 v[66:67], v[66:67], v[70:71]
 v_pk_add_f32 v[64:65], v[64:65], v[66:67]
 v_add_f32 v82, v64, v65
 s_nop 1
 v_add_f32_dpp v82, v82, v82 row_ror:4 row_mask:0xf bank_mask:0xf
 s_nop 1
 v_add_f32_dpp v82, v82, v82 row_ror:8 row_mask:0xf bank_mask:0xf
 v_mov_b32 v83, v82
 s_nop 1
 v_permlane16_swap_b32 v82, v83
 v_add_f32 v82, v82, v83
 v_mov_b32 v83, v82
 s_nop 1
 v_permlane32_swap_b32 v82, v83
 v_add_f32 v82, v82, v83
 v_mov_b32 v84, 0x3727c5ac
 v_fmac_f32 v84, 0x3b000000, v82
 v_rsq_f32 v84, v84
 s_nop 0
 v_pk_mul_f32 v[32:33], v[32:33], v[84:85] op_sel_hi:[1,0]
 v_pk_mul_f32 v[34:35], v[34:35], v[84:85] op_sel_hi:[1,0]
 v_pk_mul_f32 v[36:37], v[36:37], v[84:85] op_sel_hi:[1,0]
 v_pk_mul_f32 v[38:39], v[38:39], v[84:85] op_sel_hi:[1,0]
 v_pk_mul_f32 v[40:41], v[40:41], v[84:85] op_sel_hi:[1,0]
 v_pk_mul_f32 v[42:43], v[42:43], v[84:85] op_sel_hi:[1,0]
 v_pk_mul_f32 v[44:45], v[44:45], v[84:85] op_sel_hi:[1,0]
 v_pk_mul_f32 v[46:47], v[46:47], v[84:85] op_sel_hi:[1,0]
 v_pk_mul_f32 v[48:49], v[48:49], v[84:85] op_sel_hi:[1,0]
 v_pk_mul_f32 v[50:51], v[50:51], v[84:85] op_sel_hi:[1,0]
 v_pk_mul_f32 v[52:53], v[52:53], v[84:85] op_sel_hi:[1,0]
 v_pk_mul_f32 v[54:55], v[54:55], v[84:85] op_sel_hi:[1,0]
 v_pk_mul_f32 v[56:57], v[56:57], v[84:85] op_sel_hi:[1,0]
 v_pk_mul_f32 v[58:59], v[58:59], v[84:85] op_sel_hi:[1,0]
 v_pk_mul_f32 v[60:61], v[60:61], v[84:85] op_sel_hi:[1,0]
 v_pk_mul_f32 v[62:63], v[62:63], v[84:85] op_sel_hi:[1,0]
 v_cvt_pk_bf16_f32 v12, v32, v33
 v_cvt_pk_bf16_f32 v13, v34, v35
 v_cvt_pk_bf16_f32 v14, v36, v37
 v_cvt_pk_bf16_f32 v15, v38, v39
 buffer_store_dwordx4 v[12:15], v8, s[4:7], s36 offen offset:0 sc1
 v_cvt_pk_bf16_f32 v16, v40, v41
 v_cvt_pk_bf16_f32 v17, v42, v43
 v_cvt_pk_bf16_f32 v18, v44, v45
 v_cvt_pk_bf16_f32 v19, v46, v47
 buffer_store_dwordx4 v[16:19], v8, s[4:7], s36 offen offset:2048 sc1
 v_cvt_pk_bf16_f32 v20, v48, v49
 v_cvt_pk_bf16_f32 v21, v50, v51
 v_cvt_pk_bf16_f32 v22, v52, v53
 v_cvt_pk_bf16_f32 v23, v54, v55
 s_add_u32 s36, s36, 4096
 buffer_store_dwordx4 v[20:23], v8, s[4:7], s36 offen offset:0 sc1
 v_cvt_pk_bf16_f32 v24, v56, v57
 v_cvt_pk_bf16_f32 v25, v58, v59
 v_cvt_pk_bf16_f32 v26, v60, v61
 v_cvt_pk_bf16_f32 v27, v62, v63
 buffer_store_dwordx4 v[24:27], v8, s[4:7], s36 offen offset:2048 sc1
 s_waitcnt vmcnt(0) lgkmcnt(0)
 s_mul_i32 s60, s60, 0x9e3779b1
 s_add_u32 s60, s60, 1
 s_lshl_b32 s58, s2, 1
 s_add_u32 s58, s58, s20
 s_lshl_b32 s58, s58, 7
 s_add_u32 s58, s58, 0xf80000
 v_mov_b32 v2, s60
 v_mov_b32 v3, 0
 s_mov_b64 exec, 1
 buffer_store_dword v2, v3, s[4:7], s58 offen sc1
 s_mov_b64 exec, -1
 s_cmp_lg_u32 s20, 0
 s_cbranch_scc1 P0J2
 s_mov_b32 s16, s68
 s_and_b32 s17, s69, 0xffff
 s_mov_b32 s18, 0x4000
 s_mov_b32 s19, 0x20000
 s_lshl_b32 s35, s25, 10
 s_mov_b32 m0, 98304
 s_nop 0
 buffer_load_dwordx4 v4, s[16:19], s35 offen lds
 s_branch P0J2
DMAW1:
 s_cmp_lg_u32 s20, 3
 s_cbranch_scc1 CP4
 s_and_b32 s40, s62, 0xffffff80
 s_and_b32 s41, s63, 0xffff
 s_mov_b32 s42, L_codeend-sequential_preLN__linear_kernel_hedgehog__glu_gated_glu__prompt_kernel
 s_mov_b32 s43, 0x20000
 s_mul_i32 s35, s22, 10
 v_min_u32 v12, 9, v1
 v_add_u32 v12, s35, v12
 v_lshlrev_b32 v12, 7, v12
 buffer_load_dword v13, v12, s[40:43], 0 offen
CP4:
 s_waitcnt lgkmcnt(0)
 s_mov_b32 s12, s66
 s_and_b32 s13, s67, 0xffff
 s_mov_b32 s14, 0x180000
 s_mov_b32 s15, 0x20000
 v_lshrrev_b32 v5, 2, v1
 v_mul_u32_u24 v5, 3072, v5
 v_and_b32 v10, 3, v1
 v_lshlrev_b32 v10, 4, v10
 v_add_u32 v5, v5, v10
 s_sub_u32 s32, s20, 1
 s_lshl_b32 s33, s32, 10
 s_lshl_b32 s34, s25, 6
 s_add_u32 s33, s33, s34
 s_sub_u32 s34, s20, 2
 s_lshl_b32 s34, s34, 15
 s_and_b32 s36, s24, 3
 s_lshl_b32 s36, s36, 1
 s_and_b32 s37, s25, 1
 s_add_u32 s36, s36, s37
 s_lshl_b32 s36, s36, 2
 s_add_u32 s37, s36, 0
 s_and_b32 s37, s37, 31
 s_mul_i32 s38, s37, 49152
 s_add_u32 s38, s38, s33
 s_lshl_b32 s39, s37, 10
 s_add_u32 m0, s39, s34
 s_nop 0
 buffer_load_dwordx4 v5, s[12:15], s38 offen lds
 s_add_u32 s37, s36, 1
 s_and_b32 s37, s37, 31
 s_mul_i32 s38, s37, 49152
 s_add_u32 s38, s38, s33
 s_lshl_b32 s39, s37, 10
 s_add_u32 m0, s39, s34
 s_nop 0
 buffer_load_dwordx4 v5, s[12:15], s38 offen lds
 s_add_u32 s37, s36, 2
 s_and_b32 s37, s37, 31
 s_mul_i32 s38, s37, 49152
 s_add_u32 s38, s38, s33
 s_lshl_b32 s39, s37, 10
 s_add_u32 m0, s39, s34
 s_nop 0
 buffer_load_dwordx4 v5, s[12:15], s38 offen lds
 s_add_u32 s37, s36, 3
 s_and_b32 s37, s37, 31
 s_mul_i32 s38, s37, 49152
 s_add_u32 s38, s38, s33
 s_lshl_b32 s39, s37, 10
 s_add_u32 m0, s39, s34
 s_nop 0
 buffer_load_dwordx4 v5, s[12:15], s38 offen lds
 s_add_u32 s37, s36, 4
 s_and_b32 s37, s37, 31
 s_mul_i32 s38, s37, 49152
 s_add_u32 s38, s38, s33
 s_lshl_b32 s39, s37, 10
 s_add_u32 m0, s39, s34
 s_nop 0
 buffer_load_dwordx4 v5, s[12:15], s38 offen lds
 s_add_u32 s37, s36, 5
 s_and_b32 s37, s37, 31
 s_mul_i32 s38, s37, 49152
 s_add_u32 s38, s38, s33
 s_lshl_b32 s39, s37, 10
 s_add_u32 m0, s39, s34
 s_nop 0
 buffer_load_dwordx4 v5, s[12:15], s38 offen lds
 s_add_u32 s37, s36, 6
 s_and_b32 s37, s37, 31
 s_mul_i32 s38, s37, 49152
 s_add_u32 s38, s38, s33
 s_lshl_b32 s39, s37, 10
 s_add_u32 m0, s39, s34
 s_nop 0
 buffer_load_dwordx4 v5, s[12:15], s38 offen lds
 s_add_u32 s37, s36, 7
 s_and_b32 s37, s37, 31
 s_mul_i32 s38, s37, 49152
 s_add_u32 s38, s38, s33
 s_lshl_b32 s39, s37, 10
 s_add_u32 m0, s39, s34
 s_nop 0
 buffer_load_dwordx4 v5, s[12:15], s38 offen lds
 s_add_u32 s37, s36, 8
 s_and_b32 s37, s37, 31
 s_mul_i32 s38, s37, 49152
 s_add_u32 s38, s38, s33
 s_lshl_b32 s39, s37, 10
 s_add_u32 m0, s39, s34
 s_nop 0
 buffer_load_dwordx4 v5, s[12:15], s38 offen lds
 s_add_u32 s37, s36, 9
 s_and_b32 s37, s37, 31
 s_mul_i32 s38, s37, 49152
 s_add_u32 s38, s38, s33
 s_lshl_b32 s39, s37, 10
 s_add_u32 m0, s39, s34
 s_nop 0
 buffer_load_dwordx4 v5, s[12:15], s38 offen lds
 s_add_u32 s37, s36, 10
 s_and_b32 s37, s37, 31
 s_mul_i32 s38, s37, 49152
 s_add_u32 s38, s38, s33
 s_lshl_b32 s39, s37, 10
 s_add_u32 m0, s39, s34
 s_nop 0
 buffer_load_dwordx4 v5, s[12:15], s38 offen lds
 s_add_u32 s37, s36, 11
 s_and_b32 s37, s37, 31
 s_mul_i32 s38, s37, 49152
 s_add_u32 s38, s38, s33
 s_lshl_b32 s39, s37, 10
 s_add_u32 m0, s39, s34
 s_nop 0
 buffer_load_dwordx4 v5, s[12:15], s38 offen lds
 s_add_u32 s37, s36, 12
 s_and_b32 s37, s37, 31
 s_mul_i32 s38, s37, 49152
 s_add_u32 s38, s38, s33
 s_lshl_b32 s39, s37, 10
 s_add_u32 m0, s39, s34
 s_nop 0
 buffer_load_dwordx4 v5, s[12:15], s38 offen lds
 s_add_u32 s37, s36, 13
 s_and_b32 s37, s37, 31
 s_mul_i32 s38, s37, 49152
 s_add_u32 s38, s38, s33
 s_lshl_b32 s39, s37, 10
 s_add_u32 m0, s39, s34
 s_nop 0
 buffer_load_dwordx4 v5, s[12:15], s38 offen lds
 s_add_u32 s37, s36, 14
 s_and_b32 s37, s37, 31
 s_mul_i32 s38, s37, 49152
 s_add_u32 s38, s38, s33
 s_lshl_b32 s39, s37, 10
 s_add_u32 m0, s39, s34
 s_nop 0
 buffer_load_dwordx4 v5, s[12:15], s38 offen lds
 s_add_u32 s37, s36, 15
 s_and_b32 s37, s37, 31
 s_mul_i32 s38, s37, 49152
 s_add_u32 s38, s38, s33
 s_lshl_b32 s39, s37, 10
 s_add_u32 m0, s39, s34
 s_nop 0
 buffer_load_dwordx4 v5, s[12:15], s38 offen lds
 s_add_u32 s37, s36, 16
 s_and_b32 s37, s37, 31
 s_mul_i32 s38, s37, 49152
 s_add_u32 s38, s38, s33
 s_lshl_b32 s39, s37, 10
 s_add_u32 m0, s39, s34
 s_nop 0
 buffer_load_dwordx4 v5, s[12:15], s38 offen lds
 s_add_u32 s37, s36, 17
 s_and_b32 s37, s37, 31
 s_mul_i32 s38, s37, 49152
 s_add_u32 s38, s38, s33
 s_lshl_b32 s39, s37, 10
 s_add_u32 m0, s39, s34
 s_nop 0
 buffer_load_dwordx4 v5, s[12:15], s38 offen lds
 s_add_u32 s37, s36, 18
 s_and_b32 s37, s37, 31
 s_mul_i32 s38, s37, 49152
 s_add_u32 s38, s38, s33
 s_lshl_b32 s39, s37, 10
 s_add_u32 m0, s39, s34
 s_nop 0
 buffer_load_dwordx4 v5, s[12:15], s38 offen lds
 s_add_u32 s37, s36, 19
 s_and_b32 s37, s37, 31
 s_mul_i32 s38, s37, 49152
 s_add_u32 s38, s38, s33
 s_lshl_b32 s39, s37, 10
 s_add_u32 m0, s39, s34
 s_nop 0
 buffer_load_dwordx4 v5, s[12:15], s38 offen lds
 s_add_u32 s37, s36, 20
 s_and_b32 s37, s37, 31
 s_mul_i32 s38, s37, 49152
 s_add_u32 s38, s38, s33
 s_lshl_b32 s39, s37, 10
 s_add_u32 m0, s39, s34
 s_nop 0
 buffer_load_dwordx4 v5, s[12:15], s38 offen lds
 s_add_u32 s37, s36, 21
 s_and_b32 s37, s37, 31
 s_mul_i32 s38, s37, 49152
 s_add_u32 s38, s38, s33
 s_lshl_b32 s39, s37, 10
 s_add_u32 m0, s39, s34
 s_nop 0
 buffer_load_dwordx4 v5, s[12:15], s38 offen lds
 s_add_u32 s37, s36, 22
 s_and_b32 s37, s37, 31
 s_mul_i32 s38, s37, 49152
 s_add_u32 s38, s38, s33
 s_lshl_b32 s39, s37, 10
 s_add_u32 m0, s39, s34
 s_nop 0
 buffer_load_dwordx4 v5, s[12:15], s38 offen lds
 s_add_u32 s37, s36, 23
 s_and_b32 s37, s37, 31
 s_mul_i32 s38, s37, 49152
 s_add_u32 s38, s38, s33
 s_lshl_b32 s39, s37, 10
 s_add_u32 m0, s39, s34
 s_nop 0
 buffer_load_dwordx4 v5, s[12:15], s38 offen lds
 s_add_u32 s37, s36, 24
 s_and_b32 s37, s37, 31
 s_mul_i32 s38, s37, 49152
 s_add_u32 s38, s38, s33
 s_lshl_b32 s39, s37, 10
 s_add_u32 m0, s39, s34
 s_nop 0
 buffer_load_dwordx4 v5, s[12:15], s38 offen lds
 s_add_u32 s37, s36, 25
 s_and_b32 s37, s37, 31
 s_mul_i32 s38, s37, 49152
 s_add_u32 s38, s38, s33
 s_lshl_b32 s39, s37, 10
 s_add_u32 m0, s39, s34
 s_nop 0
 buffer_load_dwordx4 v5, s[12:15], s38 offen lds
 s_add_u32 s37, s36, 26
 s_and_b32 s37, s37, 31
 s_mul_i32 s38, s37, 49152
 s_add_u32 s38, s38, s33
 s_lshl_b32 s39, s37, 10
 s_add_u32 m0, s39, s34
 s_nop 0
 buffer_load_dwordx4 v5, s[12:15], s38 offen lds
 s_add_u32 s37, s36, 27
 s_and_b32 s37, s37, 31
 s_mul_i32 s38, s37, 49152
 s_add_u32 s38, s38, s33
 s_lshl_b32 s39, s37, 10
 s_add_u32 m0, s39, s34
 s_nop 0
 buffer_load_dwordx4 v5, s[12:15], s38 offen lds
 s_add_u32 s37, s36, 28
 s_and_b32 s37, s37, 31
 s_mul_i32 s38, s37, 49152
 s_add_u32 s38, s38, s33
 s_lshl_b32 s39, s37, 10
 s_add_u32 m0, s39, s34
 s_nop 0
 buffer_load_dwordx4 v5, s[12:15], s38 offen lds
 s_add_u32 s37, s36, 29
 s_and_b32 s37, s37, 31
 s_mul_i32 s38, s37, 49152
 s_add_u32 s38, s38, s33
 s_lshl_b32 s39, s37, 10
 s_add_u32 m0, s39, s34
 s_nop 0
 buffer_load_dwordx4 v5, s[12:15], s38 offen lds
 s_add_u32 s37, s36, 30
 s_and_b32 s37, s37, 31
 s_mul_i32 s38, s37, 49152
 s_add_u32 s38, s38, s33
 s_lshl_b32 s39, s37, 10
 s_add_u32 m0, s39, s34
 s_nop 0
 buffer_load_dwordx4 v5, s[12:15], s38 offen lds
 s_add_u32 s37, s36, 31
 s_and_b32 s37, s37, 31
 s_mul_i32 s38, s37, 49152
 s_add_u32 s38, s38, s33
 s_lshl_b32 s39, s37, 10
 s_add_u32 m0, s39, s34
 s_nop 0
 buffer_load_dwordx4 v5, s[12:15], s38 offen lds
 s_mov_b32 s59, 0xf30000
 s_load_dword s60, s[84:85], s59
 s_mov_b32 s4, s84
 s_and_b32 s5, s85, 0xffff
 s_mov_b32 s6, 0x1900000
 s_mov_b32 s7, 0x20000
 s_waitcnt vmcnt(0) lgkmcnt(0)
 s_mul_i32 s60, s60, 0x9e3779b1
 s_add_u32 s60, s60, 1
P0J2:
 s_barrier
 s_cmp_lg_u32 s20, 0
 s_cbranch_scc1 PD6
 s_lshl_b32 s35, s24, 5
 v_add_u32 v2, s35, v1
 s_lshl_b32 s35, s25, 5
 s_add_u32 s35, s35, 1
 v_mov_b32 v3, s35
 v_cmp_gt_u32 vcc, 32, v1
 s_nop 1
 v_cndmask_b32 v2, v3, v2, vcc
 v_lshlrev_b32 v2, 7, v2
 s_mov_b32 s58, 0xf80000
 s_mov_b32 s59, 262144
PL5:
 buffer_load_dword v3, v2, s[4:7], s58 offen sc1
 s_waitcnt vmcnt(0)
 v_cmp_ne_u32 vcc, s60, v3
 s_cbranch_vccz PD6
 s_sleep 2
 s_sub_u32 s59, s59, 1
 s_cmp_lg_u32 s59, 0
 s_cbranch_scc1 PL5
PD6:
 s_barrier
 s_lshl_b32 s31, s24, 2
 s_add_u32 s31, s31, s20
 s_lshl_b32 s32, s31, 15
 s_add_u32 s32, s32, 0x0
 s_add_u32 s33, s32, 4096
 v_bfe_u32 v5, v1, 3, 2
 v_lshlrev_b32 v5, 13, v5
 v_lshrrev_b32 v10, 5, v1
 v_lshlrev_b32 v10, 7, v10
 v_add_u32 v5, v5, v10
 v_and_b32 v10, 7, v1
 v_lshlrev_b32 v10, 4, v10
 v_add_u32 v5, v5, v10
 buffer_load_dwordx4 v[64:67], v5, s[4:7], s32 offen offset:0 sc1
 buffer_load_dwordx4 v[68:71], v5, s[4:7], s32 offen offset:256 sc1
 buffer_load_dwordx4 v[72:75], v5, s[4:7], s32 offen offset:512 sc1
 buffer_load_dwordx4 v[76:79], v5, s[4:7], s32 offen offset:768 sc1
 buffer_load_dwordx4 v[80:83], v5, s[4:7], s32 offen offset:1024 sc1
 buffer_load_dwordx4 v[84:87], v5, s[4:7], s32 offen offset:1280 sc1
 buffer_load_dwordx4 v[88:91], v5, s[4:7], s32 offen offset:1536 sc1
 buffer_load_dwordx4 v[92:95], v5, s[4:7], s32 offen offset:1792 sc1
 v_lshrrev_b32 v6, 5, v1
 v_mul_u32_u24 v6, 8, v6
 v_bfe_u32 v10, v1, 2, 2
 v_add_u32 v6, v6, v10
 v_mul_u32_u24 v6, 64, v6
 v_bfe_u32 v10, v1, 4, 1
 v_lshlrev_b32 v10, 5, v10
 v_add_u32 v6, v6, v10
 v_and_b32 v10, 3, v1
 v_lshlrev_b32 v10, 3, v10
 v_add_u32 v6, v6, v10
 v_add_u32 v7, 0x10000, v6
 ds_read_b64_tr_b16 v[192:193], v6 offset:0
 ds_read_b64_tr_b16 v[194:195], v6 offset:256
 ds_read_b64_tr_b16 v[196:197], v6 offset:32768
 ds_read_b64_tr_b16 v[198:199], v6 offset:33024
 ds_read_b64_tr_b16 v[200:201], v6 offset:1024
 ds_read_b64_tr_b16 v[202:203], v6 offset:1280
 ds_read_b64_tr_b16 v[204:205], v6 offset:33792
 ds_read_b64_tr_b16 v[206:207], v6 offset:34048
 ds_read_b64_tr_b16 v[208:209], v6 offset:2048
 ds_read_b64_tr_b16 v[210:211], v6 offset:2304
 s_waitcnt vmcnt(7) lgkmcnt(6)
 v_mfma_f32_32x32x16_bf16 v[32:47], v[192:195], v[64:67], 0
 ds_read_b64_tr_b16 v[212:213], v6 offset:34816
 ds_read_b64_tr_b16 v[214:215], v6 offset:35072
 buffer_load_dwordx4 v[96:99], v5, s[4:7], s32 offen offset:2048 sc1
 v_mfma_f32_32x32x16_bf16 v[48:63], v[196:199], v[64:67], 0
 ds_read_b64_tr_b16 v[216:217], v6 offset:3072
 ds_read_b64_tr_b16 v[218:219], v6 offset:3328
 s_waitcnt vmcnt(7) lgkmcnt(6)
 v_mfma_f32_32x32x16_bf16 v[32:47], v[200:203], v[68:71], v[32:47]
 ds_read_b64_tr_b16 v[220:221], v6 offset:35840
 ds_read_b64_tr_b16 v[222:223], v6 offset:36096
 buffer_load_dwordx4 v[100:103], v5, s[4:7], s32 offen offset:2304 sc1
 v_mfma_f32_32x32x16_bf16 v[48:63], v[204:207], v[68:71], v[48:63]
 ds_read_b64_tr_b16 v[192:193], v6 offset:4096
 ds_read_b64_tr_b16 v[194:195], v6 offset:4352
 s_waitcnt vmcnt(7) lgkmcnt(6)
 v_mfma_f32_32x32x16_bf16 v[32:47], v[208:211], v[72:75], v[32:47]
 ds_read_b64_tr_b16 v[196:197], v6 offset:36864
 ds_read_b64_tr_b16 v[198:199], v6 offset:37120
 buffer_load_dwordx4 v[104:107], v5, s[4:7], s32 offen offset:2560 sc1
 v_mfma_f32_32x32x16_bf16 v[48:63], v[212:215], v[72:75], v[48:63]
 ds_read_b64_tr_b16 v[200:201], v6 offset:5120
 ds_read_b64_tr_b16 v[202:203], v6 offset:5376
 s_waitcnt vmcnt(7) lgkmcnt(6)
 v_mfma_f32_32x32x16_bf16 v[32:47], v[216:219], v[76:79], v[32:47]
 ds_read_b64_tr_b16 v[204:205], v6 offset:37888
 ds_read_b64_tr_b16 v[206:207], v6 offset:38144
 buffer_load_dwordx4 v[108:111], v5, s[4:7], s32 offen offset:2816 sc1
 v_mfma_f32_32x32x16_bf16 v[48:63], v[220:223], v[76:79], v[48:63]
 ds_read_b64_tr_b16 v[208:209], v6 offset:6144
 ds_read_b64_tr_b16 v[210:211], v6 offset:6400
 s_waitcnt vmcnt(7) lgkmcnt(6)
 v_mfma_f32_32x32x16_bf16 v[32:47], v[192:195], v[80:83], v[32:47]
 ds_read_b64_tr_b16 v[212:213], v6 offset:38912
 ds_read_b64_tr_b16 v[214:215], v6 offset:39168
 buffer_load_dwordx4 v[112:115], v5, s[4:7], s32 offen offset:3072 sc1
 v_mfma_f32_32x32x16_bf16 v[48:63], v[196:199], v[80:83], v[48:63]
 ds_read_b64_tr_b16 v[216:217], v6 offset:7168
 ds_read_b64_tr_b16 v[218:219], v6 offset:7424
 s_waitcnt vmcnt(7) lgkmcnt(6)
 v_mfma_f32_32x32x16_bf16 v[32:47], v[200:203], v[84:87], v[32:47]
 ds_read_b64_tr_b16 v[220:221], v6 offset:39936
 ds_read_b64_tr_b16 v[222:223], v6 offset:40192
 buffer_load_dwordx4 v[116:119], v5, s[4:7], s32 offen offset:3328 sc1
 v_mfma_f32_32x32x16_bf16 v[48:63], v[204:207], v[84:87], v[48:63]
 ds_read_b64_tr_b16 v[192:193], v6 offset:8192
 ds_read_b64_tr_b16 v[194:195], v6 offset:8448
 s_waitcnt vmcnt(7) lgkmcnt(6)
 v_mfma_f32_32x32x16_bf16 v[32:47], v[208:211], v[88:91], v[32:47]
 ds_read_b64_tr_b16 v[196:197], v6 offset:40960
 ds_read_b64_tr_b16 v[198:199], v6 offset:41216
 buffer_load_dwordx4 v[120:123], v5, s[4:7], s32 offen offset:3584 sc1
 v_mfma_f32_32x32x16_bf16 v[48:63], v[212:215], v[88:91], v[48:63]
 ds_read_b64_tr_b16 v[200:201], v6 offset:9216
 ds_read_b64_tr_b16 v[202:203], v6 offset:9472
 s_waitcnt vmcnt(7) lgkmcnt(6)
 v_mfma_f32_32x32x16_bf16 v[32:47], v[216:219], v[92:95], v[32:47]
 ds_read_b64_tr_b16 v[204:205], v6 offset:41984
 ds_read_b64_tr_b16 v[206:207], v6 offset:42240
 buffer_load_dwordx4 v[124:127], v5, s[4:7], s32 offen offset:3840 sc1
 v_mfma_f32_32x32x16_bf16 v[48:63], v[220:223], v[92:95], v[48:63]
 ds_read_b64_tr_b16 v[208:209], v6 offset:10240
 ds_read_b64_tr_b16 v[210:211], v6 offset:10496
 s_waitcnt vmcnt(7) lgkmcnt(6)
 v_mfma_f32_32x32x16_bf16 v[32:47], v[192:195], v[96:99], v[32:47]
 ds_read_b64_tr_b16 v[212:213], v6 offset:43008
 ds_read_b64_tr_b16 v[214:215], v6 offset:43264
 buffer_load_dwordx4 v[128:131], v5, s[4:7], s33 offen offset:0 sc1
 v_mfma_f32_32x32x16_bf16 v[48:63], v[196:199], v[96:99], v[48:63]
 ds_read_b64_tr_b16 v[216:217], v6 offset:11264
 ds_read_b64_tr_b16 v[218:219], v6 offset:11520
 s_waitcnt vmcnt(7) lgkmcnt(6)
 v_mfma_f32_32x32x16_bf16 v[32:47], v[200:203], v[100:103], v[32:47]
 ds_read_b64_tr_b16 v[220:221], v6 offset:44032
 ds_read_b64_tr_b16 v[222:223], v6 offset:44288
 buffer_load_dwordx4 v[132:135], v5, s[4:7], s33 offen offset:256 sc1
 v_mfma_f32_32x32x16_bf16 v[48:63], v[204:207], v[100:103], v[48:63]
 ds_read_b64_tr_b16 v[192:193], v6 offset:12288
 ds_read_b64_tr_b16 v[194:195], v6 offset:12544
 s_waitcnt vmcnt(7) lgkmcnt(6)
 v_mfma_f32_32x32x16_bf16 v[32:47], v[208:211], v[104:107], v[32:47]
 ds_read_b64_tr_b16 v[196:197], v6 offset:45056
 ds_read_b64_tr_b16 v[198:199], v6 offset:45312
 buffer_load_dwordx4 v[136:139], v5, s[4:7], s33 offen offset:512 sc1
 v_mfma_f32_32x32x16_bf16 v[48:63], v[212:215], v[104:107], v[48:63]
 ds_read_b64_tr_b16 v[200:201], v6 offset:13312
 ds_read_b64_tr_b16 v[202:203], v6 offset:13568
 s_waitcnt vmcnt(7) lgkmcnt(6)
 v_mfma_f32_32x32x16_bf16 v[32:47], v[216:219], v[108:111], v[32:47]
 ds_read_b64_tr_b16 v[204:205], v6 offset:46080
 ds_read_b64_tr_b16 v[206:207], v6 offset:46336
 buffer_load_dwordx4 v[140:143], v5, s[4:7], s33 offen offset:768 sc1
 v_mfma_f32_32x32x16_bf16 v[48:63], v[220:223], v[108:111], v[48:63]
 ds_read_b64_tr_b16 v[208:209], v6 offset:14336
 ds_read_b64_tr_b16 v[210:211], v6 offset:14592
 s_waitcnt vmcnt(7) lgkmcnt(6)
 v_mfma_f32_32x32x16_bf16 v[32:47], v[192:195], v[112:115], v[32:47]
 ds_read_b64_tr_b16 v[212:213], v6 offset:47104
 ds_read_b64_tr_b16 v[214:215], v6 offset:47360
 buffer_load_dwordx4 v[144:147], v5, s[4:7], s33 offen offset:1024 sc1
 v_mfma_f32_32x32x16_bf16 v[48:63], v[196:199], v[112:115], v[48:63]
 ds_read_b64_tr_b16 v[216:217], v6 offset:15360
 ds_read_b64_tr_b16 v[218:219], v6 offset:15616
 s_waitcnt vmcnt(7) lgkmcnt(6)
 v_mfma_f32_32x32x16_bf16 v[32:47], v[200:203], v[116:119], v[32:47]
 ds_read_b64_tr_b16 v[220:221], v6 offset:48128
 ds_read_b64_tr_b16 v[222:223], v6 offset:48384
 buffer_load_dwordx4 v[148:151], v5, s[4:7], s33 offen offset:1280 sc1
 v_mfma_f32_32x32x16_bf16 v[48:63], v[204:207], v[116:119], v[48:63]
 ds_read_b64_tr_b16 v[192:193], v6 offset:16384
 ds_read_b64_tr_b16 v[194:195], v6 offset:16640
 s_waitcnt vmcnt(7) lgkmcnt(6)
 v_mfma_f32_32x32x16_bf16 v[32:47], v[208:211], v[120:123], v[32:47]
 ds_read_b64_tr_b16 v[196:197], v6 offset:49152
 ds_read_b64_tr_b16 v[198:199], v6 offset:49408
 buffer_load_dwordx4 v[152:155], v5, s[4:7], s33 offen offset:1536 sc1
 v_mfma_f32_32x32x16_bf16 v[48:63], v[212:215], v[120:123], v[48:63]
 ds_read_b64_tr_b16 v[200:201], v6 offset:17408
 ds_read_b64_tr_b16 v[202:203], v6 offset:17664
 s_waitcnt vmcnt(7) lgkmcnt(6)
 v_mfma_f32_32x32x16_bf16 v[32:47], v[216:219], v[124:127], v[32:47]
 ds_read_b64_tr_b16 v[204:205], v6 offset:50176
 ds_read_b64_tr_b16 v[206:207], v6 offset:50432
 buffer_load_dwordx4 v[156:159], v5, s[4:7], s33 offen offset:1792 sc1
 v_mfma_f32_32x32x16_bf16 v[48:63], v[220:223], v[124:127], v[48:63]
 ds_read_b64_tr_b16 v[208:209], v6 offset:18432
 ds_read_b64_tr_b16 v[210:211], v6 offset:18688
 s_waitcnt vmcnt(7) lgkmcnt(6)
 v_mfma_f32_32x32x16_bf16 v[32:47], v[192:195], v[128:131], v[32:47]
 ds_read_b64_tr_b16 v[212:213], v6 offset:51200
 ds_read_b64_tr_b16 v[214:215], v6 offset:51456
 buffer_load_dwordx4 v[160:163], v5, s[4:7], s33 offen offset:2048 sc1
 v_mfma_f32_32x32x16_bf16 v[48:63], v[196:199], v[128:131], v[48:63]
 ds_read_b64_tr_b16 v[216:217], v6 offset:19456
 ds_read_b64_tr_b16 v[218:219], v6 offset:19712
 s_waitcnt vmcnt(7) lgkmcnt(6)
 v_mfma_f32_32x32x16_bf16 v[32:47], v[200:203], v[132:135], v[32:47]
 ds_read_b64_tr_b16 v[220:221], v6 offset:52224
 ds_read_b64_tr_b16 v[222:223], v6 offset:52480
 buffer_load_dwordx4 v[164:167], v5, s[4:7], s33 offen offset:2304 sc1
 v_mfma_f32_32x32x16_bf16 v[48:63], v[204:207], v[132:135], v[48:63]
 ds_read_b64_tr_b16 v[192:193], v6 offset:20480
 ds_read_b64_tr_b16 v[194:195], v6 offset:20736
 s_waitcnt vmcnt(7) lgkmcnt(6)
 v_mfma_f32_32x32x16_bf16 v[32:47], v[208:211], v[136:139], v[32:47]
 ds_read_b64_tr_b16 v[196:197], v6 offset:53248
 ds_read_b64_tr_b16 v[198:199], v6 offset:53504
 buffer_load_dwordx4 v[168:171], v5, s[4:7], s33 offen offset:2560 sc1
 v_mfma_f32_32x32x16_bf16 v[48:63], v[212:215], v[136:139], v[48:63]
 ds_read_b64_tr_b16 v[200:201], v6 offset:21504
 ds_read_b64_tr_b16 v[202:203], v6 offset:21760
 s_waitcnt vmcnt(7) lgkmcnt(6)
 v_mfma_f32_32x32x16_bf16 v[32:47], v[216:219], v[140:143], v[32:47]
 ds_read_b64_tr_b16 v[204:205], v6 offset:54272
 ds_read_b64_tr_b16 v[206:207], v6 offset:54528
 buffer_load_dwordx4 v[172:175], v5, s[4:7], s33 offen offset:2816 sc1
 v_mfma_f32_32x32x16_bf16 v[48:63], v[220:223], v[140:143], v[48:63]
 ds_read_b64_tr_b16 v[208:209], v6 offset:22528
 ds_read_b64_tr_b16 v[210:211], v6 offset:22784
 s_waitcnt vmcnt(7) lgkmcnt(6)
 v_mfma_f32_32x32x16_bf16 v[32:47], v[192:195], v[144:147], v[32:47]
 ds_read_b64_tr_b16 v[212:213], v6 offset:55296
 ds_read_b64_tr_b16 v[214:215], v6 offset:55552
 buffer_load_dwordx4 v[176:179], v5, s[4:7], s33 offen offset:3072 sc1
 v_mfma_f32_32x32x16_bf16 v[48:63], v[196:199], v[144:147], v[48:63]
 ds_read_b64_tr_b16 v[216:217], v6 offset:23552
 ds_read_b64_tr_b16 v[218:219], v6 offset:23808
 s_waitcnt vmcnt(7) lgkmcnt(6)
 v_mfma_f32_32x32x16_bf16 v[32:47], v[200:203], v[148:151], v[32:47]
 ds_read_b64_tr_b16 v[220:221], v6 offset:56320
 ds_read_b64_tr_b16 v[222:223], v6 offset:56576
 buffer_load_dwordx4 v[180:183], v5, s[4:7], s33 offen offset:3328 sc1
 v_mfma_f32_32x32x16_bf16 v[48:63], v[204:207], v[148:151], v[48:63]
 ds_read_b64_tr_b16 v[192:193], v6 offset:24576
 ds_read_b64_tr_b16 v[194:195], v6 offset:24832
 s_waitcnt vmcnt(7) lgkmcnt(6)
 v_mfma_f32_32x32x16_bf16 v[32:47], v[208:211], v[152:155], v[32:47]
 ds_read_b64_tr_b16 v[196:197], v6 offset:57344
 ds_read_b64_tr_b16 v[198:199], v6 offset:57600
 buffer_load_dwordx4 v[184:187], v5, s[4:7], s33 offen offset:3584 sc1
 v_mfma_f32_32x32x16_bf16 v[48:63], v[212:215], v[152:155], v[48:63]
 ds_read_b64_tr_b16 v[200:201], v6 offset:25600
 ds_read_b64_tr_b16 v[202:203], v6 offset:25856
 s_waitcnt vmcnt(7) lgkmcnt(6)
 v_mfma_f32_32x32x16_bf16 v[32:47], v[216:219], v[156:159], v[32:47]
 ds_read_b64_tr_b16 v[204:205], v6 offset:58368
 ds_read_b64_tr_b16 v[206:207], v6 offset:58624
 buffer_load_dwordx4 v[188:191], v5, s[4:7], s33 offen offset:3840 sc1
 v_mfma_f32_32x32x16_bf16 v[48:63], v[220:223], v[156:159], v[48:63]
 ds_read_b64_tr_b16 v[208:209], v6 offset:26624
 ds_read_b64_tr_b16 v[210:211], v6 offset:26880
 s_waitcnt vmcnt(7) lgkmcnt(6)
 v_mfma_f32_32x32x16_bf16 v[32:47], v[192:195], v[160:163], v[32:47]
 ds_read_b64_tr_b16 v[212:213], v6 offset:59392
 ds_read_b64_tr_b16 v[214:215], v6 offset:59648
 v_mfma_f32_32x32x16_bf16 v[48:63], v[196:199], v[160:163], v[48:63]
 ds_read_b64_tr_b16 v[216:217], v6 offset:27648
 ds_read_b64_tr_b16 v[218:219], v6 offset:27904
 s_waitcnt vmcnt(6) lgkmcnt(6)
 v_mfma_f32_32x32x16_bf16 v[32:47], v[200:203], v[164:167], v[32:47]
 ds_read_b64_tr_b16 v[220:221], v6 offset:60416
 ds_read_b64_tr_b16 v[222:223], v6 offset:60672
 v_mfma_f32_32x32x16_bf16 v[48:63], v[204:207], v[164:167], v[48:63]
 ds_read_b64_tr_b16 v[192:193], v6 offset:28672
 ds_read_b64_tr_b16 v[194:195], v6 offset:28928
 s_waitcnt vmcnt(5) lgkmcnt(6)
 v_mfma_f32_32x32x16_bf16 v[32:47], v[208:211], v[168:171], v[32:47]
 ds_read_b64_tr_b16 v[196:197], v6 offset:61440
 ds_read_b64_tr_b16 v[198:199], v6 offset:61696
 v_mfma_f32_32x32x16_bf16 v[48:63], v[212:215], v[168:171], v[48:63]
 ds_read_b64_tr_b16 v[200:201], v6 offset:29696
 ds_read_b64_tr_b16 v[202:203], v6 offset:29952
 s_waitcnt vmcnt(4) lgkmcnt(6)
 v_mfma_f32_32x32x16_bf16 v[32:47], v[216:219], v[172:175], v[32:47]
 ds_read_b64_tr_b16 v[204:205], v6 offset:62464
 ds_read_b64_tr_b16 v[206:207], v6 offset:62720
 v_mfma_f32_32x32x16_bf16 v[48:63], v[220:223], v[172:175], v[48:63]
 ds_read_b64_tr_b16 v[208:209], v6 offset:30720
 ds_read_b64_tr_b16 v[210:211], v6 offset:30976
 s_waitcnt vmcnt(3) lgkmcnt(6)
 v_mfma_f32_32x32x16_bf16 v[32:47], v[192:195], v[176:179], v[32:47]
 ds_read_b64_tr_b16 v[212:213], v6 offset:63488
 ds_read_b64_tr_b16 v[214:215], v6 offset:63744
 v_mfma_f32_32x32x16_bf16 v[48:63], v[196:199], v[176:179], v[48:63]
 ds_read_b64_tr_b16 v[216:217], v6 offset:31744
 ds_read_b64_tr_b16 v[218:219], v6 offset:32000
 s_waitcnt vmcnt(2) lgkmcnt(6)
 v_mfma_f32_32x32x16_bf16 v[32:47], v[200:203], v[180:183], v[32:47]
 ds_read_b64_tr_b16 v[220:221], v6 offset:64512
 ds_read_b64_tr_b16 v[222:223], v6 offset:64768
 v_mfma_f32_32x32x16_bf16 v[48:63], v[204:207], v[180:183], v[48:63]
 s_waitcnt vmcnt(1) lgkmcnt(4)
 v_mfma_f32_32x32x16_bf16 v[32:47], v[208:211], v[184:187], v[32:47]
 v_mfma_f32_32x32x16_bf16 v[48:63], v[212:215], v[184:187], v[48:63]
 s_waitcnt vmcnt(0) lgkmcnt(0)
 v_mfma_f32_32x32x16_bf16 v[32:47], v[216:219], v[188:191], v[32:47]
 v_mfma_f32_32x32x16_bf16 v[48:63], v[220:223], v[188:191], v[48:63]
 s_mov_b32 s12, s66
 s_and_b32 s13, s67, 0xffff
 s_mov_b32 s14, 0x180000
 s_mov_b32 s15, 0x20000
 v_lshrrev_b32 v14, 2, v1
 v_mul_u32_u24 v14, 3072, v14
 v_and_b32 v10, 3, v1
 v_lshlrev_b32 v10, 4, v10
 v_add_u32 v14, v14, v10
 s_mul_i32 s33, s20, 393216
 s_lshl_b32 s34, s25, 6
 s_add_u32 s33, s33, s34
 s_lshl_b32 s34, s20, 13
 s_add_u32 s35, s33, 0
 s_add_u32 m0, s34, 65536
 s_nop 0
 buffer_load_dwordx4 v14, s[12:15], s35 offen lds
 s_add_u32 s35, s33, 49152
 s_add_u32 m0, s34, 66560
 s_nop 0
 buffer_load_dwordx4 v14, s[12:15], s35 offen lds
 s_add_u32 s35, s33, 98304
 s_add_u32 m0, s34, 67584
 s_nop 0
 buffer_load_dwordx4 v14, s[12:15], s35 offen lds
 s_add_u32 s35, s33, 147456
 s_add_u32 m0, s34, 68608
 s_nop 0
 buffer_load_dwordx4 v14, s[12:15], s35 offen lds
 s_add_u32 s35, s33, 196608
 s_add_u32 m0, s34, 69632
 s_nop 0
 buffer_load_dwordx4 v14, s[12:15], s35 offen lds
 s_add_u32 s35, s33, 245760
 s_add_u32 m0, s34, 70656
 s_nop 0
 buffer_load_dwordx4 v14, s[12:15], s35 offen lds
 s_add_u32 s35, s33, 294912
 s_add_u32 m0, s34, 71680
 s_nop 0
 buffer_load_dwordx4 v14, s[12:15], s35 offen lds
 s_add_u32 s35, s33, 344064
 s_add_u32 m0, s34, 72704
 s_nop 0
 buffer_load_dwordx4 v14, s[12:15], s35 offen lds
 s_cmp_eq_u32 s20, 1
 s_cbranch_scc1 TC9
 s_cmp_eq_u32 s20, 2
 s_cbranch_scc1 TC10
 s_cmp_eq_u32 s20, 3
 s_cbranch_scc1 TC11
TC12:
 v_mov_b32 v253, 0
 s_mov_b32 s52, 0xf30000
 s_mov_b64 exec, 1
 buffer_load_dword v250, v253, s[4:7], s52 offen
 buffer_load_dword v251, v253, s[4:7], s52 offen
 s_mov_b64 exec, -1
 s_branch TC8
TC9:
 s_cmp_ge_u32 s2, 224
 s_cbranch_scc1 TC12
 s_cmp_ge_u32 s2, 112
 s_cselect_b32 s54, 112, 0
 s_cselect_b32 s52, s76, s74
 s_cselect_b32 s53, s77, s75
 s_sub_u32 s55, s2, s54
 s_mov_b32 s48, s52
 s_and_b32 s49, s53, 0xffff
 s_mov_b32 s50, 0x1c0000
 s_mov_b32 s51, 0x20000
 s_and_b32 s56, s55, 3
 s_mul_i32 s56, s56, 458752
 s_lshr_b32 s55, s55, 2
 s_lshl_b32 s55, s55, 7
 s_add_u32 s56, s56, s55
 v_mul_u32_u24 v253, 3584, v1
 buffer_load_dword v250, v253, s[48:51], s56 offen
 s_add_u32 s56, s56, 229376
 buffer_load_dword v251, v253, s[48:51], s56 offen
 s_branch TC8
TC10:
 s_cmp_lt_u32 s2, 144
 s_cbranch_scc1 TC12
 s_mov_b32 s48, s78
 s_and_b32 s49, s79, 0xffff
 s_mov_b32 s50, 0x1c0000
 s_mov_b32 s51, 0x20000
 s_sub_u32 s56, s2, 144
 s_lshl_b32 s56, s56, 14
 v_lshlrev_b32 v253, 7, v1
 buffer_load_dword v250, v253, s[48:51], s56 offen
 s_add_u32 s56, s56, 8192
 buffer_load_dword v251, v253, s[48:51], s56 offen
 s_branch TC8
TC11:
 s_mov_b32 s48, s70
 s_and_b32 s49, s71, 0xffff
 s_mov_b32 s50, 0x80000
 s_mov_b32 s51, 0x20000
 s_lshl_b32 s56, s22, 14
 v_lshlrev_b32 v253, 7, v1
 buffer_load_dword v250, v253, s[48:51], s56 offen
 s_add_u32 s56, s56, 8192
 buffer_load_dword v251, v253, s[48:51], s56 offen
TC8:
 v_lshrrev_b32 v8, 5, v1
 v_lshlrev_b32 v8, 2, v8
 v_bfe_u32 v10, v1, 2, 2
 v_add_u32 v8, v8, v10
 v_lshlrev_b32 v8, 5, v8
 v_and_b32 v10, 3, v1
 v_lshlrev_b32 v10, 3, v10
 v_add_u32 v8, v8, v10
 v_add_u32 v8, 98304, v8
 v_and_b32 v9, 16, v1
 v_lshlrev_b32 v9, 11, v9
 v_lshlrev_b32 v10, 16, v9
 v_or_b32 v9, v9, v10
 ds_read_b64_tr_b16 v[224:225], v8 offset:0
 ds_read_b64_tr_b16 v[226:227], v8 offset:256
 ds_read_b64_tr_b16 v[228:229], v8 offset:512
 ds_read_b64_tr_b16 v[230:231], v8 offset:768
 s_mul_i32 s35, s20, 9216
 s_add_u32 s35, s35, 102400
 v_and_b32 v10, 31, v1
 v_mul_u32_u24 v10, 72, v10
 v_lshrrev_b32 v12, 5, v1
 v_lshlrev_b32 v12, 3, v12
 v_add_u32 v10, v10, v12
 v_add_u32 v10, s35, v10
 v_lshrrev_b32 v11, 5, v1
 v_mul_u32_u24 v11, 8, v11
 v_bfe_u32 v12, v1, 2, 2
 v_add_u32 v11, v11, v12
 v_mul_u32_u24 v11, 72, v11
 v_bfe_u32 v12, v1, 4, 1
 v_lshlrev_b32 v12, 5, v12
 v_add_u32 v11, v11, v12
 v_and_b32 v12, 3, v1
 v_lshlrev_b32 v12, 3, v12
 v_add_u32 v11, v11, v12
 v_add_u32 v11, s35, v11
 v_cvt_pk_bf16_f32 v232, v32, v33
 v_cvt_pk_bf16_f32 v233, v34, v35
 v_cvt_pk_bf16_f32 v234, v36, v37
 v_cvt_pk_bf16_f32 v235, v38, v39
 v_cvt_pk_bf16_f32 v236, v40, v41
 v_cvt_pk_bf16_f32 v237, v42, v43
 v_cvt_pk_bf16_f32 v238, v44, v45
 v_cvt_pk_bf16_f32 v239, v46, v47
 s_waitcnt lgkmcnt(0)
 v_xor_b32 v224, v224, v9
 v_xor_b32 v225, v225, v9
 v_xor_b32 v226, v226, v9
 v_xor_b32 v227, v227, v9
 v_xor_b32 v228, v228, v9
 v_xor_b32 v229, v229, v9
 v_xor_b32 v230, v230, v9
 v_xor_b32 v231, v231, v9
 v_mfma_f32_32x32x16_bf16 v[192:207], v[224:227], v[232:235], 0
 s_nop 0
 v_mfma_f32_32x32x16_bf16 v[208:223], v[228:231], v[236:239], 0
 v_cvt_pk_bf16_f32 v240, v48, v49
 v_cvt_pk_bf16_f32 v241, v50, v51
 v_cvt_pk_bf16_f32 v242, v52, v53
 v_cvt_pk_bf16_f32 v243, v54, v55
 v_cvt_pk_bf16_f32 v244, v56, v57
 v_cvt_pk_bf16_f32 v245, v58, v59
 v_cvt_pk_bf16_f32 v246, v60, v61
 v_cvt_pk_bf16_f32 v247, v62, v63
 v_mov_b32 v12, 0x3f803f80
 v_mov_b32 v13, 0x3f803f80
 ds_write_b64 v10, v[240:241] offset:4608
 ds_write_b64 v10, v[12:13] offset:4640
 ds_write_b64 v10, v[242:243] offset:4624
 ds_write_b64 v10, v[12:13] offset:4656
 ds_write_b64 v10, v[244:245] offset:6912
 ds_write_b64 v10, v[12:13] offset:6944
 ds_write_b64 v10, v[246:247] offset:6928
 ds_write_b64 v10, v[12:13] offset:6960
 s_mov_b32 s36, 0x3fb8aa3b
 s_mov_b32 s37, 0x3fb8aa3b
 v_max3_f32 v48, v192, v193, v194
 v_max3_f32 v52, v200, v201, v202
 v_max3_f32 v56, v208, v209, v210
 v_max3_f32 v60, v216, v217, v218
 v_max3_f32 v48, v48, v195, v196
 v_max3_f32 v52, v52, v203, v204
 v_max3_f32 v56, v56, v211, v212
 v_max3_f32 v60, v60, v219, v220
 v_max3_f32 v48, v48, v197, v198
 v_max3_f32 v52, v52, v205, v206
 v_max3_f32 v56, v56, v213, v214
 v_max3_f32 v60, v60, v221, v222
 v_max_f32 v48, v48, v199
 v_max_f32 v52, v52, v207
 v_max_f32 v56, v56, v215
 v_max_f32 v60, v60, v223
 v_mov_b32 v49, v48
 v_mov_b32 v53, v52
 v_mov_b32 v57, v56
 v_mov_b32 v61, v60
 v_permlane32_swap_b32 v48, v49
 v_permlane32_swap_b32 v52, v53
 v_permlane32_swap_b32 v56, v57
 v_permlane32_swap_b32 v60, v61
 v_max_f32 v48, v48, v49
 v_max_f32 v52, v52, v53
 v_max_f32 v56, v56, v57
 v_max_f32 v60, v60, v61
 v_mul_f32 v48, s36, v48
 v_mul_f32 v52, s36, v52
 v_mul_f32 v56, s36, v56
 v_mul_f32 v60, s36, v60
 v_pk_fma_f32 v[192:193], v[192:193], s[36:37], v[48:49] op_sel_hi:[1,1,0] neg_lo:[0,0,1] neg_hi:[0,0,1]
 v_pk_fma_f32 v[194:195], v[194:195], s[36:37], v[48:49] op_sel_hi:[1,1,0] neg_lo:[0,0,1] neg_hi:[0,0,1]
 v_pk_fma_f32 v[196:197], v[196:197], s[36:37], v[48:49] op_sel_hi:[1,1,0] neg_lo:[0,0,1] neg_hi:[0,0,1]
 v_pk_fma_f32 v[198:199], v[198:199], s[36:37], v[48:49] op_sel_hi:[1,1,0] neg_lo:[0,0,1] neg_hi:[0,0,1]
 v_pk_fma_f32 v[200:201], v[200:201], s[36:37], v[52:53] op_sel_hi:[1,1,0] neg_lo:[0,0,1] neg_hi:[0,0,1]
 v_pk_fma_f32 v[202:203], v[202:203], s[36:37], v[52:53] op_sel_hi:[1,1,0] neg_lo:[0,0,1] neg_hi:[0,0,1]
 v_pk_fma_f32 v[204:205], v[204:205], s[36:37], v[52:53] op_sel_hi:[1,1,0] neg_lo:[0,0,1] neg_hi:[0,0,1]
 v_pk_fma_f32 v[206:207], v[206:207], s[36:37], v[52:53] op_sel_hi:[1,1,0] neg_lo:[0,0,1] neg_hi:[0,0,1]
 v_pk_fma_f32 v[208:209], v[208:209], s[36:37], v[56:57] op_sel_hi:[1,1,0] neg_lo:[0,0,1] neg_hi:[0,0,1]
 v_pk_fma_f32 v[210:211], v[210:211], s[36:37], v[56:57] op_sel_hi:[1,1,0] neg_lo:[0,0,1] neg_hi:[0,0,1]
 v_pk_fma_f32 v[212:213], v[212:213], s[36:37], v[56:57] op_sel_hi:[1,1,0] neg_lo:[0,0,1] neg_hi:[0,0,1]
 v_pk_fma_f32 v[214:215], v[214:215], s[36:37], v[56:57] op_sel_hi:[1,1,0] neg_lo:[0,0,1] neg_hi:[0,0,1]
 v_pk_fma_f32 v[216:217], v[216:217], s[36:37], v[60:61] op_sel_hi:[1,1,0] neg_lo:[0,0,1] neg_hi:[0,0,1]
 v_pk_fma_f32 v[218:219], v[218:219], s[36:37], v[60:61] op_sel_hi:[1,1,0] neg_lo:[0,0,1] neg_hi:[0,0,1]
 v_pk_fma_f32 v[220:221], v[220:221], s[36:37], v[60:61] op_sel_hi:[1,1,0] neg_lo:[0,0,1] neg_hi:[0,0,1]
 v_pk_fma_f32 v[222:223], v[222:223], s[36:37], v[60:61] op_sel_hi:[1,1,0] neg_lo:[0,0,1] neg_hi:[0,0,1]
 v_exp_f32 v192, v192
 v_exp_f32 v193, v193
 v_exp_f32 v194, v194
 v_exp_f32 v195, v195
 v_exp_f32 v196, v196
 v_exp_f32 v197, v197
 v_exp_f32 v198, v198
 v_exp_f32 v199, v199
 v_exp_f32 v200, v200
 v_exp_f32 v201, v201
 v_exp_f32 v202, v202
 v_exp_f32 v203, v203
 v_exp_f32 v204, v204
 v_exp_f32 v205, v205
 v_exp_f32 v206, v206
 v_exp_f32 v207, v207
 v_exp_f32 v208, v208
 v_exp_f32 v209, v209
 v_exp_f32 v210, v210
 v_exp_f32 v211, v211
 v_exp_f32 v212, v212
 v_exp_f32 v213, v213
 v_exp_f32 v214, v214
 v_exp_f32 v215, v215
 v_exp_f32 v216, v216
 v_exp_f32 v217, v217
 v_exp_f32 v218, v218
 v_exp_f32 v219, v219
 v_exp_f32 v220, v220
 v_exp_f32 v221, v221
 v_exp_f32 v222, v222
 v_exp_f32 v223, v223
 v_pk_add_f32 v[50:51], v[192:193], v[194:195]
 v_pk_add_f32 v[54:55], v[200:201], v[202:203]
 v_pk_add_f32 v[58:59], v[208:209], v[210:211]
 v_pk_add_f32 v[62:63], v[216:217], v[218:219]
 v_pk_add_f32 v[48:49], v[196:197], v[198:199]
 v_pk_add_f32 v[52:53], v[204:205], v[206:207]
 v_pk_add_f32 v[56:57], v[212:213], v[214:215]
 v_pk_add_f32 v[60:61], v[220:221], v[222:223]
 v_pk_add_f32 v[48:49], v[48:49], v[50:51]
 v_pk_add_f32 v[52:53], v[52:53], v[54:55]
 v_pk_add_f32 v[56:57], v[56:57], v[58:59]
 v_pk_add_f32 v[60:61], v[60:61], v[62:63]
 v_add_f32 v48, v48, v49
 v_add_f32 v52, v52, v53
 v_add_f32 v56, v56, v57
 v_add_f32 v60, v60, v61
 v_mov_b32 v49, v48
 v_mov_b32 v53, v52
 v_mov_b32 v57, v56
 v_mov_b32 v61, v60
 v_permlane32_swap_b32 v48, v49
 v_permlane32_swap_b32 v52, v53
 v_permlane32_swap_b32 v56, v57
 v_permlane32_swap_b32 v60, v61
 v_add_f32 v48, v48, v49
 v_add_f32 v52, v52, v53
 v_add_f32 v56, v56, v57
 v_add_f32 v60, v60, v61
 v_rcp_f32 v48, v48
 v_rcp_f32 v52, v52
 v_rcp_f32 v56, v56
 v_rcp_f32 v60, v60
 v_pk_mul_f32 v[192:193], v[192:193], v[48:49] op_sel_hi:[1,0]
 v_pk_mul_f32 v[194:195], v[194:195], v[48:49] op_sel_hi:[1,0]
 v_pk_mul_f32 v[196:197], v[196:197], v[48:49] op_sel_hi:[1,0]
 v_pk_mul_f32 v[198:199], v[198:199], v[48:49] op_sel_hi:[1,0]
 v_pk_mul_f32 v[200:201], v[200:201], v[52:53] op_sel_hi:[1,0]
 v_pk_mul_f32 v[202:203], v[202:203], v[52:53] op_sel_hi:[1,0]
 v_pk_mul_f32 v[204:205], v[204:205], v[52:53] op_sel_hi:[1,0]
 v_pk_mul_f32 v[206:207], v[206:207], v[52:53] op_sel_hi:[1,0]
 v_pk_mul_f32 v[208:209], v[208:209], v[56:57] op_sel_hi:[1,0]
 v_pk_mul_f32 v[210:211], v[210:211], v[56:57] op_sel_hi:[1,0]
 v_pk_mul_f32 v[212:213], v[212:213], v[56:57] op_sel_hi:[1,0]
 v_pk_mul_f32 v[214:215], v[214:215], v[56:57] op_sel_hi:[1,0]
 v_pk_mul_f32 v[216:217], v[216:217], v[60:61] op_sel_hi:[1,0]
 v_pk_mul_f32 v[218:219], v[218:219], v[60:61] op_sel_hi:[1,0]
 v_pk_mul_f32 v[220:221], v[220:221], v[60:61] op_sel_hi:[1,0]
 v_pk_mul_f32 v[222:223], v[222:223], v[60:61] op_sel_hi:[1,0]
 v_cvt_pk_bf16_f32 v32, v192, v193
 v_cvt_pk_bf16_f32 v33, v194, v195
 v_cvt_pk_bf16_f32 v34, v196, v197
 v_cvt_pk_bf16_f32 v35, v198, v199
 v_cvt_pk_bf16_f32 v36, v200, v201
 v_cvt_pk_bf16_f32 v37, v202, v203
 v_cvt_pk_bf16_f32 v38, v204, v205
 v_cvt_pk_bf16_f32 v39, v206, v207
 v_cvt_pk_bf16_f32 v40, v208, v209
 v_cvt_pk_bf16_f32 v41, v210, v211
 v_cvt_pk_bf16_f32 v42, v212, v213
 v_cvt_pk_bf16_f32 v43, v214, v215
 v_cvt_pk_bf16_f32 v44, v216, v217
 v_cvt_pk_bf16_f32 v45, v218, v219
 v_cvt_pk_bf16_f32 v46, v220, v221
 v_cvt_pk_bf16_f32 v47, v222, v223
 ds_write_b64 v10, v[32:33] offset:0
 ds_write_b64 v10, v[34:35] offset:16
 ds_write_b64 v10, v[36:37] offset:32
 ds_write_b64 v10, v[38:39] offset:48
 ds_write_b64 v10, v[40:41] offset:2304
 ds_write_b64 v10, v[42:43] offset:2320
 ds_write_b64 v10, v[44:45] offset:2336
 ds_write_b64 v10, v[46:47] offset:2352
 s_waitcnt lgkmcnt(0)
 ds_read_b64_tr_b16 v[192:193], v11 offset:0
 ds_read_b64_tr_b16 v[194:195], v11 offset:288
 ds_read_b64_tr_b16 v[196:197], v11 offset:4608
 ds_read_b64_tr_b16 v[198:199], v11 offset:4896
 ds_read_b64_tr_b16 v[200:201], v11 offset:1152
 ds_read_b64_tr_b16 v[202:203], v11 offset:1440
 ds_read_b64_tr_b16 v[204:205], v11 offset:5760
 ds_read_b64_tr_b16 v[206:207], v11 offset:6048
 ds_read_b64_tr_b16 v[208:209], v11 offset:2304
 ds_read_b64_tr_b16 v[210:211], v11 offset:2592
 ds_read_b64_tr_b16 v[212:213], v11 offset:6912
 ds_read_b64_tr_b16 v[214:215], v11 offset:7200
 ds_read_b64_tr_b16 v[216:217], v11 offset:3456
 ds_read_b64_tr_b16 v[218:219], v11 offset:3744
 ds_read_b64_tr_b16 v[220:221], v11 offset:8064
 ds_read_b64_tr_b16 v[222:223], v11 offset:8352
 s_mul_i32 s35, s20, 4352
 s_add_u32 s35, s35, 139264
 v_and_b32 v12, 31, v1
 v_lshlrev_b32 v12, 4, v12
 v_lshrrev_b32 v13, 5, v1
 v_mul_u32_u24 v13, 272, v13
 v_add_u32 v12, v12, v13
 v_add_u32 v12, s35, v12
 s_waitcnt lgkmcnt(8)
 v_mfma_f32_32x32x16_bf16 v[32:47], v[192:195], v[196:199], 0
 v_mfma_f32_32x32x16_bf16 v[32:47], v[200:203], v[204:207], v[32:47]
 s_waitcnt lgkmcnt(0)
 v_mfma_f32_32x32x16_bf16 v[48:63], v[208:211], v[212:215], 0
 v_mfma_f32_32x32x16_bf16 v[48:63], v[216:219], v[220:223], v[48:63]
 s_mov_b32 exec_lo, 0x1ffff
 s_mov_b32 exec_hi, 0x1ffff
 s_nop 6
 ds_write_b128 v12, v[32:35] offset:0
 ds_write_b128 v12, v[36:39] offset:544
 ds_write_b128 v12, v[40:43] offset:1088
 ds_write_b128 v12, v[44:47] offset:1632
 ds_write_b128 v12, v[48:51] offset:2176
 ds_write_b128 v12, v[52:55] offset:2720
 ds_write_b128 v12, v[56:59] offset:3264
 ds_write_b128 v12, v[60:63] offset:3808
 s_mov_b64 exec, -1
 s_waitcnt vmcnt(2) lgkmcnt(0)
 s_barrier
 v_lshlrev_b32 v12, 2, v0
 s_mul_i32 s35, s25, 4352
 s_add_u32 s35, s35, 0x400000
 v_add_u32 v13, 139264, v12
 ds_read_b32 v32, v13 offset:0
 ds_read_b32 v33, v13 offset:4352
 ds_read_b32 v34, v13 offset:8704
 ds_read_b32 v35, v13 offset:13056
 ds_read_b32 v36, v13 offset:1024
 ds_read_b32 v37, v13 offset:5376
 ds_read_b32 v38, v13 offset:9728
 ds_read_b32 v39, v13 offset:14080
 ds_read_b32 v40, v13 offset:2048
 ds_read_b32 v41, v13 offset:6400
 ds_read_b32 v42, v13 offset:10752
 ds_read_b32 v43, v13 offset:15104
 ds_read_b32 v44, v13 offset:3072
 ds_read_b32 v45, v13 offset:7424
 ds_read_b32 v46, v13 offset:11776
 ds_read_b32 v47, v13 offset:16128
 ds_read_b32 v48, v13 offset:4096
 ds_read_b32 v49, v13 offset:8448
 ds_read_b32 v50, v13 offset:12800
 ds_read_b32 v51, v13 offset:17152
 s_waitcnt lgkmcnt(15)
 v_add_f32 v32, v32, v33
 v_add_f32 v34, v34, v35
 v_add_f32 v32, v32, v34
 buffer_atomic_add_f32 v32, v12, s[4:7], s35 offen offset:0
 s_waitcnt lgkmcnt(12)
 v_add_f32 v36, v36, v37
 v_add_f32 v38, v38, v39
 v_add_f32 v36, v36, v38
 buffer_atomic_add_f32 v36, v12, s[4:7], s35 offen offset:1024
 s_waitcnt lgkmcnt(8)
 v_add_f32 v40, v40, v41
 v_add_f32 v42, v42, v43
 v_add_f32 v40, v40, v42
 buffer_atomic_add_f32 v40, v12, s[4:7], s35 offen offset:2048
 s_waitcnt lgkmcnt(4)
 v_add_f32 v44, v44, v45
 v_add_f32 v46, v46, v47
 v_add_f32 v44, v44, v46
 buffer_atomic_add_f32 v44, v12, s[4:7], s35 offen offset:3072
 s_waitcnt lgkmcnt(0)
 v_add_f32 v48, v48, v49
 v_add_f32 v50, v50, v51
 v_add_f32 v48, v48, v50
 s_cmp_lg_u32 s20, 0
 s_cbranch_scc1 AT13
 s_add_u32 s35, s35, 4096
 buffer_atomic_add_f32 v48, v12, s[4:7], s35 offen
AT13:
 v_lshrrev_b32 v14, 3, v1
 v_lshlrev_b32 v14, 10, v14
 v_bfe_u32 v10, v1, 4, 1
 v_lshlrev_b32 v10, 2, v10
 v_xor_b32 v10, v10, v1
 v_and_b32 v10, 7, v10
 v_lshlrev_b32 v10, 4, v10
 v_add_u32 v14, v14, v10
 v_add_u32 v15, 7168, v14
 s_mov_b32 s8, s70
 s_and_b32 s9, s71, 0xffff
 s_mov_b32 s10, 0x80000
 s_mov_b32 s11, 0x20000
 s_lshl_b32 s40, s20, 17
 s_lshl_b32 s41, s27, 7
 s_add_u32 s40, s40, s41
 s_lshl_b32 s41, s20, 14
 ds_read_b64_tr_b16 v[192:193], v7 offset:0
 ds_read_b64_tr_b16 v[194:195], v7 offset:256
 ds_read_b64_tr_b16 v[196:197], v7 offset:1024
 ds_read_b64_tr_b16 v[198:199], v7 offset:1280
 ds_read_b64_tr_b16 v[200:201], v7 offset:2048
 ds_read_b64_tr_b16 v[202:203], v7 offset:2304
 ds_read_b64_tr_b16 v[204:205], v7 offset:3072
 ds_read_b64_tr_b16 v[206:207], v7 offset:3328
 ds_read_b64_tr_b16 v[208:209], v7 offset:4096
 ds_read_b64_tr_b16 v[210:211], v7 offset:4352
 s_waitcnt lgkmcnt(6)
 v_mfma_f32_32x32x16_bf16 v[16:31], v[192:195], v[64:67], 0
 ds_read_b64_tr_b16 v[212:213], v7 offset:5120
 ds_read_b64_tr_b16 v[214:215], v7 offset:5376
 s_cmp_ge_u32 s2, 224
 s_cbranch_scc1 CS15
 s_cmp_ge_u32 s2, 112
 s_cselect_b32 s54, 112, 0
 s_cselect_b32 s52, s76, s74
 s_cselect_b32 s53, s77, s75
 s_sub_u32 s55, s2, s54
 s_mov_b32 s48, s52
 s_and_b32 s49, s53, 0xffff
 s_mov_b32 s50, 0x1c0000
 s_mov_b32 s51, 0x20000
 s_lshr_b32 s56, s55, 2
 s_and_b32 s57, s55, 3
 s_lshl_b32 s52, s57, 2
 s_add_u32 s52, s52, s20
 s_mul_i32 s52, s52, 114688
 s_lshl_b32 s53, s56, 7
 s_add_u32 s52, s52, s53
 v_lshrrev_b32 v56, 3, v1
 v_mul_u32_u24 v56, 3584, v56
 v_bfe_u32 v57, v1, 4, 1
 v_lshlrev_b32 v57, 2, v57
 v_xor_b32 v57, v57, v1
 v_and_b32 v57, 7, v57
 v_lshlrev_b32 v57, 4, v57
 v_add_u32 v56, v56, v57
 s_lshl_b32 s53, s20, 12
 s_add_u32 s53, s53, 102400
 s_add_u32 s54, s52, 0
 s_add_u32 m0, s53, 0
 s_nop 0
 buffer_load_dwordx4 v56, s[48:51], s54 offen lds
 s_add_u32 s54, s52, 28672
 s_add_u32 m0, s53, 1024
 s_nop 0
 buffer_load_dwordx4 v56, s[48:51], s54 offen lds
 s_add_u32 s54, s52, 57344
 s_add_u32 m0, s53, 2048
 s_nop 0
 buffer_load_dwordx4 v56, s[48:51], s54 offen lds
 s_add_u32 s54, s52, 86016
 s_add_u32 m0, s53, 3072
 s_nop 0
 buffer_load_dwordx4 v56, s[48:51], s54 offen lds
CS15:
 s_cmp_lt_u32 s2, 144
 s_cbranch_scc1 DT16
 s_mov_b32 s48, s78
 s_and_b32 s49, s79, 0xffff
 s_mov_b32 s50, 0x1c0000
 s_mov_b32 s51, 0x20000
 s_sub_u32 s54, s2, 144
 s_lshl_b32 s54, s54, 14
 s_lshl_b32 s55, s20, 12
 s_add_u32 s54, s54, s55
 s_add_u32 s55, s55, 119808
 v_xor_b32 v56, 0, v1
 v_lshlrev_b32 v56, 4, v56
 s_add_u32 s56, s54, 0
 s_add_u32 m0, s55, 0
 s_nop 0
 buffer_load_dwordx4 v56, s[48:51], s56 offen lds
 v_xor_b32 v56, 4, v1
 v_lshlrev_b32 v56, 4, v56
 s_add_u32 s56, s54, 1024
 s_add_u32 m0, s55, 1024
 s_nop 0
 buffer_load_dwordx4 v56, s[48:51], s56 offen lds
 v_xor_b32 v56, 8, v1
 v_lshlrev_b32 v56, 4, v56
 s_add_u32 s56, s54, 2048
 s_add_u32 m0, s55, 2048
 s_nop 0
 buffer_load_dwordx4 v56, s[48:51], s56 offen lds
 v_xor_b32 v56, 12, v1
 v_lshlrev_b32 v56, 4, v56
 s_add_u32 s56, s54, 3072
 s_add_u32 m0, s55, 3072
 s_nop 0
 buffer_load_dwordx4 v56, s[48:51], s56 offen lds
DT16:
 v_mfma_f32_32x32x16_bf16 v[16:31], v[196:199], v[68:71], v[16:31]
 ds_read_b64_tr_b16 v[216:217], v7 offset:6144
 ds_read_b64_tr_b16 v[218:219], v7 offset:6400
 s_waitcnt lgkmcnt(6)
 v_mfma_f32_32x32x16_bf16 v[16:31], v[200:203], v[72:75], v[16:31]
 ds_read_b64_tr_b16 v[220:221], v7 offset:7168
 ds_read_b64_tr_b16 v[222:223], v7 offset:7424
 v_mfma_f32_32x32x16_bf16 v[16:31], v[204:207], v[76:79], v[16:31]
 ds_read_b64_tr_b16 v[192:193], v7 offset:8192
 ds_read_b64_tr_b16 v[194:195], v7 offset:8448
 s_add_u32 s42, s40, 0
 s_add_u32 m0, s41, 0
 s_nop 0
 buffer_load_dwordx4 v14, s[8:11], s42 offen lds
 buffer_load_dwordx4 v15, s[8:11], s42 offen offset:1024 lds
 s_waitcnt lgkmcnt(6)
 v_mfma_f32_32x32x16_bf16 v[16:31], v[208:211], v[80:83], v[16:31]
 ds_read_b64_tr_b16 v[196:197], v7 offset:9216
 ds_read_b64_tr_b16 v[198:199], v7 offset:9472
 v_mfma_f32_32x32x16_bf16 v[16:31], v[212:215], v[84:87], v[16:31]
 ds_read_b64_tr_b16 v[200:201], v7 offset:10240
 ds_read_b64_tr_b16 v[202:203], v7 offset:10496
 s_waitcnt lgkmcnt(6)
 v_mfma_f32_32x32x16_bf16 v[16:31], v[216:219], v[88:91], v[16:31]
 ds_read_b64_tr_b16 v[204:205], v7 offset:11264
 ds_read_b64_tr_b16 v[206:207], v7 offset:11520
 s_add_u32 s42, s40, 16384
 s_add_u32 m0, s41, 2048
 s_nop 0
 buffer_load_dwordx4 v14, s[8:11], s42 offen lds
 buffer_load_dwordx4 v15, s[8:11], s42 offen offset:1024 lds
 v_mfma_f32_32x32x16_bf16 v[16:31], v[220:223], v[92:95], v[16:31]
 ds_read_b64_tr_b16 v[208:209], v7 offset:12288
 ds_read_b64_tr_b16 v[210:211], v7 offset:12544
 s_waitcnt lgkmcnt(6)
 v_mfma_f32_32x32x16_bf16 v[16:31], v[192:195], v[96:99], v[16:31]
 ds_read_b64_tr_b16 v[212:213], v7 offset:13312
 ds_read_b64_tr_b16 v[214:215], v7 offset:13568
 v_mfma_f32_32x32x16_bf16 v[16:31], v[196:199], v[100:103], v[16:31]
 ds_read_b64_tr_b16 v[216:217], v7 offset:14336
 ds_read_b64_tr_b16 v[218:219], v7 offset:14592
 s_add_u32 s42, s40, 32768
 s_add_u32 m0, s41, 4096
 s_nop 0
 buffer_load_dwordx4 v14, s[8:11], s42 offen lds
 buffer_load_dwordx4 v15, s[8:11], s42 offen offset:1024 lds
 s_waitcnt lgkmcnt(6)
 v_mfma_f32_32x32x16_bf16 v[16:31], v[200:203], v[104:107], v[16:31]
 ds_read_b64_tr_b16 v[220:221], v7 offset:15360
 ds_read_b64_tr_b16 v[222:223], v7 offset:15616
 v_mfma_f32_32x32x16_bf16 v[16:31], v[204:207], v[108:111], v[16:31]
 ds_read_b64_tr_b16 v[192:193], v7 offset:16384
 ds_read_b64_tr_b16 v[194:195], v7 offset:16640
 s_waitcnt lgkmcnt(6)
 v_mfma_f32_32x32x16_bf16 v[16:31], v[208:211], v[112:115], v[16:31]
 ds_read_b64_tr_b16 v[196:197], v7 offset:17408
 ds_read_b64_tr_b16 v[198:199], v7 offset:17664
 s_add_u32 s42, s40, 49152
 s_add_u32 m0, s41, 6144
 s_nop 0
 buffer_load_dwordx4 v14, s[8:11], s42 offen lds
 buffer_load_dwordx4 v15, s[8:11], s42 offen offset:1024 lds
 v_mfma_f32_32x32x16_bf16 v[16:31], v[212:215], v[116:119], v[16:31]
 ds_read_b64_tr_b16 v[200:201], v7 offset:18432
 ds_read_b64_tr_b16 v[202:203], v7 offset:18688
 s_waitcnt lgkmcnt(6)
 v_mfma_f32_32x32x16_bf16 v[16:31], v[216:219], v[120:123], v[16:31]
 ds_read_b64_tr_b16 v[204:205], v7 offset:19456
 ds_read_b64_tr_b16 v[206:207], v7 offset:19712
 v_mfma_f32_32x32x16_bf16 v[16:31], v[220:223], v[124:127], v[16:31]
 ds_read_b64_tr_b16 v[208:209], v7 offset:20480
 ds_read_b64_tr_b16 v[210:211], v7 offset:20736
 s_add_u32 s42, s40, 65536
 s_add_u32 m0, s41, 8192
 s_nop 0
 buffer_load_dwordx4 v14, s[8:11], s42 offen lds
 buffer_load_dwordx4 v15, s[8:11], s42 offen offset:1024 lds
 s_waitcnt lgkmcnt(6)
 v_mfma_f32_32x32x16_bf16 v[16:31], v[192:195], v[128:131], v[16:31]
 ds_read_b64_tr_b16 v[212:213], v7 offset:21504
 ds_read_b64_tr_b16 v[214:215], v7 offset:21760
 v_mfma_f32_32x32x16_bf16 v[16:31], v[196:199], v[132:135], v[16:31]
 ds_read_b64_tr_b16 v[216:217], v7 offset:22528
 ds_read_b64_tr_b16 v[218:219], v7 offset:22784
 s_waitcnt lgkmcnt(6)
 v_mfma_f32_32x32x16_bf16 v[16:31], v[200:203], v[136:139], v[16:31]
 ds_read_b64_tr_b16 v[220:221], v7 offset:23552
 ds_read_b64_tr_b16 v[222:223], v7 offset:23808
 s_add_u32 s42, s40, 81920
 s_add_u32 m0, s41, 10240
 s_nop 0
 buffer_load_dwordx4 v14, s[8:11], s42 offen lds
 buffer_load_dwordx4 v15, s[8:11], s42 offen offset:1024 lds
 v_mfma_f32_32x32x16_bf16 v[16:31], v[204:207], v[140:143], v[16:31]
 ds_read_b64_tr_b16 v[192:193], v7 offset:24576
 ds_read_b64_tr_b16 v[194:195], v7 offset:24832
 s_waitcnt lgkmcnt(6)
 v_mfma_f32_32x32x16_bf16 v[16:31], v[208:211], v[144:147], v[16:31]
 ds_read_b64_tr_b16 v[196:197], v7 offset:25600
 ds_read_b64_tr_b16 v[198:199], v7 offset:25856
 v_mfma_f32_32x32x16_bf16 v[16:31], v[212:215], v[148:151], v[16:31]
 ds_read_b64_tr_b16 v[200:201], v7 offset:26624
 ds_read_b64_tr_b16 v[202:203], v7 offset:26880
 s_add_u32 s42, s40, 98304
 s_add_u32 m0, s41, 12288
 s_nop 0
 buffer_load_dwordx4 v14, s[8:11], s42 offen lds
 buffer_load_dwordx4 v15, s[8:11], s42 offen offset:1024 lds
 s_waitcnt lgkmcnt(6)
 v_mfma_f32_32x32x16_bf16 v[16:31], v[216:219], v[152:155], v[16:31]
 ds_read_b64_tr_b16 v[204:205], v7 offset:27648
 ds_read_b64_tr_b16 v[206:207], v7 offset:27904
 v_mfma_f32_32x32x16_bf16 v[16:31], v[220:223], v[156:159], v[16:31]
 ds_read_b64_tr_b16 v[208:209], v7 offset:28672
 ds_read_b64_tr_b16 v[210:211], v7 offset:28928
 s_waitcnt lgkmcnt(6)
 v_mfma_f32_32x32x16_bf16 v[16:31], v[192:195], v[160:163], v[16:31]
 ds_read_b64_tr_b16 v[212:213], v7 offset:29696
 ds_read_b64_tr_b16 v[214:215], v7 offset:29952
 s_add_u32 s42, s40, 114688
 s_add_u32 m0, s41, 14336
 s_nop 0
 buffer_load_dwordx4 v14, s[8:11], s42 offen lds
 buffer_load_dwordx4 v15, s[8:11], s42 offen offset:1024 lds
 v_mfma_f32_32x32x16_bf16 v[16:31], v[196:199], v[164:167], v[16:31]
 ds_read_b64_tr_b16 v[216:217], v7 offset:30720
 ds_read_b64_tr_b16 v[218:219], v7 offset:30976
 s_waitcnt lgkmcnt(6)
 v_mfma_f32_32x32x16_bf16 v[16:31], v[200:203], v[168:171], v[16:31]
 ds_read_b64_tr_b16 v[220:221], v7 offset:31744
 ds_read_b64_tr_b16 v[222:223], v7 offset:32000
 v_mfma_f32_32x32x16_bf16 v[16:31], v[204:207], v[172:175], v[16:31]
 s_waitcnt lgkmcnt(4)
 v_mfma_f32_32x32x16_bf16 v[16:31], v[208:211], v[176:179], v[16:31]
 v_mfma_f32_32x32x16_bf16 v[16:31], v[212:215], v[180:183], v[16:31]
 s_waitcnt lgkmcnt(0)
 v_mfma_f32_32x32x16_bf16 v[16:31], v[216:219], v[184:187], v[16:31]
 v_mfma_f32_32x32x16_bf16 v[16:31], v[220:223], v[188:191], v[16:31]
 s_nop 11
 v_cvt_pk_bf16_f32 v232, v16, v17
 v_cvt_pk_bf16_f32 v233, v18, v19
 v_cvt_pk_bf16_f32 v234, v20, v21
 v_cvt_pk_bf16_f32 v235, v22, v23
 v_cvt_pk_bf16_f32 v236, v24, v25
 v_cvt_pk_bf16_f32 v237, v26, v27
 v_cvt_pk_bf16_f32 v238, v28, v29
 v_cvt_pk_bf16_f32 v239, v30, v31
 v_mfma_f32_32x32x16_bf16 v[64:79], v[224:227], v[232:235], 0
 s_nop 0
 v_mfma_f32_32x32x16_bf16 v[80:95], v[228:231], v[236:239], 0
 s_barrier
 s_nop 8
 v_max3_f32 v160, v64, v65, v66
 v_max3_f32 v164, v72, v73, v74
 v_max3_f32 v168, v80, v81, v82
 v_max3_f32 v172, v88, v89, v90
 v_max3_f32 v160, v160, v67, v68
 v_max3_f32 v164, v164, v75, v76
 v_max3_f32 v168, v168, v83, v84
 v_max3_f32 v172, v172, v91, v92
 v_max3_f32 v160, v160, v69, v70
 v_max3_f32 v164, v164, v77, v78
 v_max3_f32 v168, v168, v85, v86
 v_max3_f32 v172, v172, v93, v94
 v_max_f32 v160, v160, v71
 v_max_f32 v164, v164, v79
 v_max_f32 v168, v168, v87
 v_max_f32 v172, v172, v95
 v_mov_b32 v161, v160
 v_mov_b32 v165, v164
 v_mov_b32 v169, v168
 v_mov_b32 v173, v172
 v_permlane32_swap_b32 v160, v161
 v_permlane32_swap_b32 v164, v165
 v_permlane32_swap_b32 v168, v169
 v_permlane32_swap_b32 v172, v173
 v_max_f32 v160, v160, v161
 v_max_f32 v164, v164, v165
 v_max_f32 v168, v168, v169
 v_max_f32 v172, v172, v173
 v_mul_f32 v160, s36, v160
 v_mul_f32 v164, s36, v164
 v_mul_f32 v168, s36, v168
 v_mul_f32 v172, s36, v172
 v_pk_fma_f32 v[64:65], v[64:65], s[36:37], v[160:161] op_sel_hi:[1,1,0] neg_lo:[0,0,1] neg_hi:[0,0,1]
 v_pk_fma_f32 v[66:67], v[66:67], s[36:37], v[160:161] op_sel_hi:[1,1,0] neg_lo:[0,0,1] neg_hi:[0,0,1]
 v_pk_fma_f32 v[68:69], v[68:69], s[36:37], v[160:161] op_sel_hi:[1,1,0] neg_lo:[0,0,1] neg_hi:[0,0,1]
 v_pk_fma_f32 v[70:71], v[70:71], s[36:37], v[160:161] op_sel_hi:[1,1,0] neg_lo:[0,0,1] neg_hi:[0,0,1]
 v_pk_fma_f32 v[72:73], v[72:73], s[36:37], v[164:165] op_sel_hi:[1,1,0] neg_lo:[0,0,1] neg_hi:[0,0,1]
 v_pk_fma_f32 v[74:75], v[74:75], s[36:37], v[164:165] op_sel_hi:[1,1,0] neg_lo:[0,0,1] neg_hi:[0,0,1]
 v_pk_fma_f32 v[76:77], v[76:77], s[36:37], v[164:165] op_sel_hi:[1,1,0] neg_lo:[0,0,1] neg_hi:[0,0,1]
 v_pk_fma_f32 v[78:79], v[78:79], s[36:37], v[164:165] op_sel_hi:[1,1,0] neg_lo:[0,0,1] neg_hi:[0,0,1]
 v_pk_fma_f32 v[80:81], v[80:81], s[36:37], v[168:169] op_sel_hi:[1,1,0] neg_lo:[0,0,1] neg_hi:[0,0,1]
 v_pk_fma_f32 v[82:83], v[82:83], s[36:37], v[168:169] op_sel_hi:[1,1,0] neg_lo:[0,0,1] neg_hi:[0,0,1]
 v_pk_fma_f32 v[84:85], v[84:85], s[36:37], v[168:169] op_sel_hi:[1,1,0] neg_lo:[0,0,1] neg_hi:[0,0,1]
 v_pk_fma_f32 v[86:87], v[86:87], s[36:37], v[168:169] op_sel_hi:[1,1,0] neg_lo:[0,0,1] neg_hi:[0,0,1]
 v_pk_fma_f32 v[88:89], v[88:89], s[36:37], v[172:173] op_sel_hi:[1,1,0] neg_lo:[0,0,1] neg_hi:[0,0,1]
 v_pk_fma_f32 v[90:91], v[90:91], s[36:37], v[172:173] op_sel_hi:[1,1,0] neg_lo:[0,0,1] neg_hi:[0,0,1]
 v_pk_fma_f32 v[92:93], v[92:93], s[36:37], v[172:173] op_sel_hi:[1,1,0] neg_lo:[0,0,1] neg_hi:[0,0,1]
 v_pk_fma_f32 v[94:95], v[94:95], s[36:37], v[172:173] op_sel_hi:[1,1,0] neg_lo:[0,0,1] neg_hi:[0,0,1]
 v_exp_f32 v64, v64
 v_exp_f32 v65, v65
 v_exp_f32 v66, v66
 v_exp_f32 v67, v67
 v_exp_f32 v68, v68
 v_exp_f32 v69, v69
 v_exp_f32 v70, v70
 v_exp_f32 v71, v71
 v_exp_f32 v72, v72
 v_exp_f32 v73, v73
 v_exp_f32 v74, v74
 v_exp_f32 v75, v75
 v_exp_f32 v76, v76
 v_exp_f32 v77, v77
 v_exp_f32 v78, v78
 v_exp_f32 v79, v79
 v_exp_f32 v80, v80
 v_exp_f32 v81, v81
 v_exp_f32 v82, v82
 v_exp_f32 v83, v83
 v_exp_f32 v84, v84
 v_exp_f32 v85, v85
 v_exp_f32 v86, v86
 v_exp_f32 v87, v87
 v_exp_f32 v88, v88
 v_exp_f32 v89, v89
 v_exp_f32 v90, v90
 v_exp_f32 v91, v91
 v_exp_f32 v92, v92
 v_exp_f32 v93, v93
 v_exp_f32 v94, v94
 v_exp_f32 v95, v95
 v_pk_add_f32 v[162:163], v[64:65], v[66:67]
 v_pk_add_f32 v[166:167], v[72:73], v[74:75]
 v_pk_add_f32 v[170:171], v[80:81], v[82:83]
 v_pk_add_f32 v[174:175], v[88:89], v[90:91]
 v_pk_add_f32 v[160:161], v[68:69], v[70:71]
 v_pk_add_f32 v[164:165], v[76:77], v[78:79]
 v_pk_add_f32 v[168:169], v[84:85], v[86:87]
 v_pk_add_f32 v[172:173], v[92:93], v[94:95]
 v_pk_add_f32 v[160:161], v[160:161], v[162:163]
 v_pk_add_f32 v[164:165], v[164:165], v[166:167]
 v_pk_add_f32 v[168:169], v[168:169], v[170:171]
 v_pk_add_f32 v[172:173], v[172:173], v[174:175]
 v_add_f32 v160, v160, v161
 v_add_f32 v164, v164, v165
 v_add_f32 v168, v168, v169
 v_add_f32 v172, v172, v173
 v_mov_b32 v161, v160
 v_mov_b32 v165, v164
 v_mov_b32 v169, v168
 v_mov_b32 v173, v172
 v_permlane32_swap_b32 v160, v161
 v_permlane32_swap_b32 v164, v165
 v_permlane32_swap_b32 v168, v169
 v_permlane32_swap_b32 v172, v173
 v_add_f32 v160, v160, v161
 v_add_f32 v164, v164, v165
 v_add_f32 v168, v168, v169
 v_add_f32 v172, v172, v173
 v_rcp_f32 v160, v160
 v_rcp_f32 v164, v164
 v_rcp_f32 v168, v168
 v_rcp_f32 v172, v172
 v_pk_mul_f32 v[64:65], v[64:65], v[160:161] op_sel_hi:[1,0]
 v_pk_mul_f32 v[66:67], v[66:67], v[160:161] op_sel_hi:[1,0]
 v_pk_mul_f32 v[68:69], v[68:69], v[160:161] op_sel_hi:[1,0]
 v_pk_mul_f32 v[70:71], v[70:71], v[160:161] op_sel_hi:[1,0]
 v_pk_mul_f32 v[72:73], v[72:73], v[164:165] op_sel_hi:[1,0]
 v_pk_mul_f32 v[74:75], v[74:75], v[164:165] op_sel_hi:[1,0]
 v_pk_mul_f32 v[76:77], v[76:77], v[164:165] op_sel_hi:[1,0]
 v_pk_mul_f32 v[78:79], v[78:79], v[164:165] op_sel_hi:[1,0]
 v_pk_mul_f32 v[80:81], v[80:81], v[168:169] op_sel_hi:[1,0]
 v_pk_mul_f32 v[82:83], v[82:83], v[168:169] op_sel_hi:[1,0]
 v_pk_mul_f32 v[84:85], v[84:85], v[168:169] op_sel_hi:[1,0]
 v_pk_mul_f32 v[86:87], v[86:87], v[168:169] op_sel_hi:[1,0]
 v_pk_mul_f32 v[88:89], v[88:89], v[172:173] op_sel_hi:[1,0]
 v_pk_mul_f32 v[90:91], v[90:91], v[172:173] op_sel_hi:[1,0]
 v_pk_mul_f32 v[92:93], v[92:93], v[172:173] op_sel_hi:[1,0]
 v_pk_mul_f32 v[94:95], v[94:95], v[172:173] op_sel_hi:[1,0]
 v_cvt_pk_bf16_f32 v144, v64, v65
 v_cvt_pk_bf16_f32 v145, v66, v67
 v_cvt_pk_bf16_f32 v146, v68, v69
 v_cvt_pk_bf16_f32 v147, v70, v71
 v_cvt_pk_bf16_f32 v148, v72, v73
 v_cvt_pk_bf16_f32 v149, v74, v75
 v_cvt_pk_bf16_f32 v150, v76, v77
 v_cvt_pk_bf16_f32 v151, v78, v79
 v_cvt_pk_bf16_f32 v152, v80, v81
 v_cvt_pk_bf16_f32 v153, v82, v83
 v_cvt_pk_bf16_f32 v154, v84, v85
 v_cvt_pk_bf16_f32 v155, v86, v87
 v_cvt_pk_bf16_f32 v156, v88, v89
 v_cvt_pk_bf16_f32 v157, v90, v91
 v_cvt_pk_bf16_f32 v158, v92, v93
 v_cvt_pk_bf16_f32 v159, v94, v95
 s_waitcnt vmcnt(16)
 s_barrier
 s_cmp_lg_u32 s20, 0
 s_cbranch_scc1 AR17
 s_lshl_b32 s58, s25, 9
 s_add_u32 s58, s58, 0xf90000
 v_mov_b32 v2, 1
 v_mov_b32 v3, 0
 s_mov_b64 exec, 1
 buffer_atomic_add v2, v3, s[4:7], s58 offen sc0 sc1
 s_waitcnt vmcnt(0)
 v_readfirstlane_b32 s59, v2
 s_mov_b64 exec, -1
 s_nop 0
 s_cmp_lg_u32 s59, 15
 s_cbranch_scc1 AR17
 s_lshl_b32 s58, s25, 7
 s_add_u32 s58, s58, 0xfa0000
 v_mov_b32 v2, s60
 s_mov_b64 exec, 1
 buffer_store_dword v2, v3, s[4:7], s58 offen sc1
 s_mov_b64 exec, -1
AR17:
 v_and_b32 v12, 31, v1
 v_min_u32 v12, 16, v12
 v_lshlrev_b32 v12, 4, v12
 v_lshrrev_b32 v13, 5, v1
 v_mul_u32_u24 v13, 272, v13
 v_add_u32 v12, v12, v13
 s_cmp_eq_u32 s20, 0
 s_cbranch_scc1 BK18
 s_branch PD21
BK18:
 s_lshl_b32 s58, s25, 7
 s_add_u32 s58, s58, 0xfa0000
 v_mov_b32 v2, 0
 s_mov_b32 s59, 262144
PL20:
 buffer_load_dword v3, v2, s[4:7], s58 offen sc1
 s_waitcnt vmcnt(0)
 v_cmp_ne_u32 vcc, s60, v3
 s_cbranch_vccz PD21
 s_sleep 2
 s_sub_u32 s59, s59, 1
 s_cmp_lg_u32 s59, 0
 s_cbranch_scc1 PL20
PD21:
 s_barrier
 s_mul_i32 s35, s25, 4352
 s_add_u32 s35, s35, 0x400000
 buffer_load_dwordx4 v[64:67], v12, s[4:7], s35 offen offset:0 sc1
 buffer_load_dwordx4 v[68:71], v12, s[4:7], s35 offen offset:544 sc1
 buffer_load_dwordx4 v[72:75], v12, s[4:7], s35 offen offset:1088 sc1
 buffer_load_dwordx4 v[76:79], v12, s[4:7], s35 offen offset:1632 sc1
 buffer_load_dwordx4 v[80:83], v12, s[4:7], s35 offen offset:2176 sc1
 buffer_load_dwordx4 v[84:87], v12, s[4:7], s35 offen offset:2720 sc1
 buffer_load_dwordx4 v[88:91], v12, s[4:7], s35 offen offset:3264 sc1
 buffer_load_dwordx4 v[92:95], v12, s[4:7], s35 offen offset:3808 sc1
 s_cmp_ge_u32 s2, 224
 s_cbranch_scc1 CS23
 s_lshl_b32 s40, s20, 12
 s_add_u32 s40, s40, 102400
 v_lshrrev_b32 v18, 5, v1
 v_lshlrev_b32 v18, 2, v18
 v_bfe_u32 v20, v1, 2, 2
 v_add_u32 v18, v18, v20
 v_lshlrev_b32 v18, 7, v18
 v_bfe_u32 v20, v1, 3, 1
 v_lshlrev_b32 v20, 6, v20
 v_add_u32 v18, v18, v20
 v_bfe_u32 v20, v1, 4, 1
 v_lshlrev_b32 v20, 5, v20
 v_add_u32 v18, v18, v20
 v_and_b32 v20, 3, v1
 v_lshlrev_b32 v20, 3, v20
 v_add_u32 v18, v18, v20
 v_xor_b32 v19, 64, v18
 v_add_u32 v18, s40, v18
 v_add_u32 v19, s40, v19
 v_mov_b32 v20, 0x3f803f80
 v_mov_b32 v21, 0x3f803f80
 v_mov_b32 v22, 0x3f803f80
 v_mov_b32 v23, 0x3f803f80
 ds_read_b64_tr_b16 v[24:25], v18 offset:0
 ds_read_b64_tr_b16 v[26:27], v18 offset:1024
 ds_read_b64_tr_b16 v[28:29], v19 offset:0
 ds_read_b64_tr_b16 v[30:31], v19 offset:1024
 ds_read_b64_tr_b16 v[32:33], v18 offset:2048
 ds_read_b64_tr_b16 v[34:35], v18 offset:3072
 ds_read_b64_tr_b16 v[36:37], v19 offset:2048
 ds_read_b64_tr_b16 v[38:39], v19 offset:3072
 s_cmp_ge_u32 s2, 112
 s_cselect_b32 s36, 112, 0
 s_cselect_b32 s39, 256, 0
 s_sub_u32 s36, s2, s36
 s_lshr_b32 s37, s36, 2
 s_and_b32 s38, s36, 3
 s_lshl_b32 s41, s37, 17
 s_lshl_b32 s38, s38, 13
 s_add_u32 s41, s41, s38
 s_lshl_b32 s38, s20, 11
 s_add_u32 s41, s41, s38
 s_add_u32 s41, s41, s39
 s_add_u32 s41, s41, 0x1000000
 v_bfe_u32 v16, v1, 4, 1
 v_lshlrev_b32 v16, 15, v16
 v_lshrrev_b32 v17, 5, v1
 v_lshlrev_b32 v17, 9, v17
 v_add_u32 v16, v16, v17
 v_and_b32 v17, 15, v1
 v_lshlrev_b32 v17, 4, v17
 v_add_u32 v16, v16, v17
 s_waitcnt lgkmcnt(0)
 buffer_store_dwordx4 v[24:27], v16, s[4:7], s41 offen offset:0 sc1
 buffer_store_dwordx4 v[32:35], v16, s[4:7], s41 offen offset:1024 sc1
 s_add_u32 s41, s41, 65536
 buffer_store_dwordx4 v[28:31], v16, s[4:7], s41 offen offset:0 sc1
 buffer_store_dwordx4 v[36:39], v16, s[4:7], s41 offen offset:1024 sc1
 v_mfma_f32_32x32x16_bf16 v[160:175], v[20:23], v[24:27], 0
 v_mfma_f32_32x32x16_bf16 v[160:175], v[20:23], v[32:35], v[160:175]
 v_mfma_f32_32x32x16_bf16 v[176:191], v[20:23], v[28:31], 0
 v_mfma_f32_32x32x16_bf16 v[176:191], v[20:23], v[36:39], v[176:191]
 s_lshl_b32 s40, s20, 8
 s_add_u32 s40, s40, 147456
 v_lshlrev_b32 v18, 2, v1
 v_add_u32 v18, s40, v18
 s_mov_b32 exec_hi, 0
 s_nop 4
 ds_write_b32 v18, v160
 s_nop 0
 ds_write_b32 v18, v176 offset:128
 s_mov_b64 exec, -1
 s_branch CS22
CS23:
 v_mov_b32 v18, 0
 s_mov_b32 s40, 0xf30000
 s_mov_b64 exec, 1
 buffer_load_dword v250, v18, s[4:7], s40 offen
 buffer_load_dword v250, v18, s[4:7], s40 offen
 buffer_load_dword v250, v18, s[4:7], s40 offen
 buffer_load_dword v250, v18, s[4:7], s40 offen
 s_mov_b64 exec, -1
CS22:
 s_waitcnt vmcnt(8)
 v_cvt_pk_bf16_f32 v96, v64, v65
 v_cvt_pk_bf16_f32 v97, v66, v67
 v_cvt_pk_bf16_f32 v98, v68, v69
 v_cvt_pk_bf16_f32 v99, v70, v71
 v_cvt_pk_bf16_f32 v100, v72, v73
 v_cvt_pk_bf16_f32 v101, v74, v75
 v_cvt_pk_bf16_f32 v102, v76, v77
 v_cvt_pk_bf16_f32 v103, v78, v79
 v_mfma_f32_32x32x16_bf16 v[16:31], v[96:99], v[144:147], 0
 s_nop 0
 v_mfma_f32_32x32x16_bf16 v[16:31], v[100:103], v[148:151], v[16:31]
 s_waitcnt vmcnt(4)
 v_cvt_pk_bf16_f32 v104, v80, v81
 v_cvt_pk_bf16_f32 v105, v82, v83
 v_cvt_pk_bf16_f32 v106, v84, v85
 v_cvt_pk_bf16_f32 v107, v86, v87
 v_cvt_pk_bf16_f32 v108, v88, v89
 v_cvt_pk_bf16_f32 v109, v90, v91
 v_cvt_pk_bf16_f32 v110, v92, v93
 v_cvt_pk_bf16_f32 v111, v94, v95
 v_mfma_f32_32x32x16_bf16 v[32:47], v[104:107], v[152:155], 0
 s_nop 0
 v_mfma_f32_32x32x16_bf16 v[32:47], v[108:111], v[156:159], v[32:47]
 s_lshl_b32 s35, s31, 5
 s_lshl_b32 s36, s25, 1
 s_add_u32 s35, s35, s36
 s_lshl_b32 s35, s35, 10
 s_add_u32 s35, s35, 0x200000
 v_add_f32 v24, 0x358637bd, v24
 v_rcp_f32 v24, v24
 s_nop 0
 v_pk_mul_f32 v[16:17], v[16:17], v[24:25] op_sel_hi:[1,0]
 v_pk_mul_f32 v[18:19], v[18:19], v[24:25] op_sel_hi:[1,0]
 v_pk_mul_f32 v[20:21], v[20:21], v[24:25] op_sel_hi:[1,0]
 v_pk_mul_f32 v[22:23], v[22:23], v[24:25] op_sel_hi:[1,0]
 v_cvt_pk_bf16_f32 v112, v16, v17
 v_cvt_pk_bf16_f32 v113, v18, v19
 v_cvt_pk_bf16_f32 v114, v20, v21
 v_cvt_pk_bf16_f32 v115, v22, v23
 buffer_store_dwordx4 v[112:115], v4, s[4:7], s35 offen offset:0 sc1
 v_add_f32 v40, 0x358637bd, v40
 v_rcp_f32 v40, v40
 s_nop 0
 v_pk_mul_f32 v[32:33], v[32:33], v[40:41] op_sel_hi:[1,0]
 v_pk_mul_f32 v[34:35], v[34:35], v[40:41] op_sel_hi:[1,0]
 v_pk_mul_f32 v[36:37], v[36:37], v[40:41] op_sel_hi:[1,0]
 v_pk_mul_f32 v[38:39], v[38:39], v[40:41] op_sel_hi:[1,0]
 v_cvt_pk_bf16_f32 v116, v32, v33
 v_cvt_pk_bf16_f32 v117, v34, v35
 v_cvt_pk_bf16_f32 v118, v36, v37
 v_cvt_pk_bf16_f32 v119, v38, v39
 buffer_store_dwordx4 v[116:119], v4, s[4:7], s35 offen offset:1024 sc1
 s_cmp_lt_u32 s2, 144
 s_cbranch_scc1 DT24
 v_bfe_u32 v18, v1, 2, 2
 v_lshrrev_b32 v19, 5, v1
 v_lshlrev_b32 v19, 2, v19
 v_add_u32 v19, v19, v18
 v_lshlrev_b32 v19, 10, v19
 v_lshlrev_b32 v18, 6, v18
 v_add_u32 v18, v18, v19
 v_bfe_u32 v19, v1, 4, 1
 v_lshlrev_b32 v19, 5, v19
 v_add_u32 v18, v18, v19
 v_and_b32 v19, 3, v1
 v_lshlrev_b32 v19, 3, v19
 v_add_u32 v18, v18, v19
 s_lshl_b32 s35, s20, 8
 s_add_u32 s35, s35, 119808
 v_xor_b32 v19, 0, v18
 v_add_u32 v19, s35, v19
 ds_read_b64_tr_b16 v[40:41], v19
 ds_read_b64_tr_b16 v[42:43], v19 offset:8192
 v_xor_b32 v19, 64, v18
 v_add_u32 v19, s35, v19
 ds_read_b64_tr_b16 v[44:45], v19
 ds_read_b64_tr_b16 v[46:47], v19 offset:8192
 v_xor_b32 v19, 128, v18
 v_add_u32 v19, s35, v19
 ds_read_b64_tr_b16 v[48:49], v19
 ds_read_b64_tr_b16 v[50:51], v19 offset:8192
 v_xor_b32 v19, 192, v18
 v_add_u32 v19, s35, v19
 ds_read_b64_tr_b16 v[52:53], v19
 ds_read_b64_tr_b16 v[54:55], v19 offset:8192
 s_sub_u32 s36, s2, 144
 s_lshl_b32 s36, s36, 14
 s_lshl_b32 s37, s20, 12
 s_add_u32 s36, s36, s37
 s_add_u32 s36, s36, 0x1400000
 s_waitcnt lgkmcnt(0)
 buffer_store_dwordx4 v[40:43], v4, s[4:7], s36 offen offset:0 sc1
 buffer_store_dwordx4 v[44:47], v4, s[4:7], s36 offen offset:1024 sc1
 buffer_store_dwordx4 v[48:51], v4, s[4:7], s36 offen offset:2048 sc1
 buffer_store_dwordx4 v[52:55], v4, s[4:7], s36 offen offset:3072 sc1
DT24:
 s_waitcnt vmcnt(0) lgkmcnt(0)
 s_barrier
 s_cmp_lg_u32 s20, 0
 s_cbranch_scc1 AR25
 s_lshl_b32 s58, s24, 4
 s_add_u32 s58, s58, s25
 s_lshl_b32 s58, s58, 7
 s_add_u32 s58, s58, 0xfb0000
 v_mov_b32 v2, s60
 v_mov_b32 v3, 0
 s_mov_b64 exec, 1
 buffer_store_dword v2, v3, s[4:7], s58 offen sc1
 s_mov_b64 exec, -1
AR25:
 s_cmp_lt_u32 s2, 144
 s_cbranch_scc1 DT26
 s_cmp_lg_u32 s20, 2
 s_cbranch_scc1 DT26
 s_sub_u32 s50, s2, 144
 s_lshl_b32 s50, s50, 2
 s_add_u32 s50, s50, 0xf26000
 v_mov_b32 v40, s60
 v_mov_b32 v41, 0
 s_mov_b64 exec, 1
 buffer_store_dword v40, v41, s[4:7], s50 offen sc1
 s_mov_b64 exec, -1
DT26:
 s_cmp_ge_u32 s2, 224
 s_cbranch_scc1 CS27
 s_cmp_lg_u32 s20, 1
 s_cbranch_scc1 CS27
 v_lshlrev_b32 v40, 2, v1
 v_add_u32 v40, 147456, v40
 ds_read_b32 v42, v40 offset:0
 ds_read_b32 v43, v40 offset:256
 ds_read_b32 v44, v40 offset:512
 ds_read_b32 v45, v40 offset:768
 s_cmp_ge_u32 s2, 112
 s_cselect_b32 s50, 112, 0
 s_cselect_b32 s53, 64, 0
 s_sub_u32 s50, s2, s50
 s_lshr_b32 s51, s50, 2
 s_and_b32 s52, s50, 3
 s_mul_i32 s54, s52, 14336
 s_lshl_b32 s55, s51, 9
 s_add_u32 s54, s54, s55
 s_add_u32 s54, s54, s53
 s_add_u32 s54, s54, 0xf00000
 v_and_b32 v40, 15, v1
 v_lshlrev_b32 v40, 2, v40
 v_lshrrev_b32 v41, 4, v1
 v_lshlrev_b32 v41, 7, v41
 v_add_u32 v40, v40, v41
 s_waitcnt lgkmcnt(0)
 v_add_f32 v42, v42, v43
 v_add_f32 v44, v44, v45
 v_add_f32 v42, v42, v44
 buffer_store_dword v42, v40, s[4:7], s54 offen sc1
CS27:
 s_cmp_ge_u32 s2, 224
 s_cbranch_scc1 CS28
 s_cmp_lg_u32 s20, 1
 s_cbranch_scc1 CS28
 s_cmp_ge_u32 s2, 112
 s_cselect_b32 s50, 112, 0
 s_cselect_b32 s53, 4, 0
 s_sub_u32 s50, s2, s50
 s_lshr_b32 s51, s50, 2
 s_and_b32 s52, s50, 3
 s_lshl_b32 s54, s51, 3
 s_add_u32 s54, s54, s53
 s_add_u32 s54, s54, s52
 s_lshl_b32 s54, s54, 2
 s_add_u32 s54, s54, 0xf25000
 s_waitcnt vmcnt(0)
 v_mov_b32 v40, s60
 v_mov_b32 v41, 0
 s_mov_b64 exec, 1
 buffer_store_dword v40, v41, s[4:7], s54 offen sc1
 s_mov_b64 exec, -1
CS28:
 s_lshr_b32 s31, s26, 1
 s_lshr_b32 s32, s20, 1
 s_and_b32 s33, s20, 1
 v_lshrrev_b32 v6, 5, v1
 v_lshlrev_b32 v6, 2, v6
 v_bfe_u32 v10, v1, 2, 2
 v_add_u32 v6, v6, v10
 v_lshlrev_b32 v6, 7, v6
 v_bfe_u32 v10, v1, 3, 1
 v_lshlrev_b32 v10, 6, v10
 v_add_u32 v6, v6, v10
 v_bfe_u32 v10, v1, 4, 1
 v_lshlrev_b32 v10, 5, v10
 v_add_u32 v6, v6, v10
 v_and_b32 v10, 3, v1
 v_lshlrev_b32 v10, 3, v10
 v_add_u32 v6, v6, v10
 v_xor_b32 v8, 64, v6
 s_lshl_b32 s34, s33, 6
 v_xor_b32 v6, s34, v6
 s_lshl_b32 s34, s32, 15
 s_add_u32 s34, s34, 65536
 v_add_u32 v7, s34, v4
 v_and_b32 v9, 31, v1
 v_lshlrev_b32 v9, 10, v9
 v_lshrrev_b32 v10, 5, v1
 v_lshlrev_b32 v10, 3, v10
 v_add_u32 v9, v9, v10
 s_lshl_b32 s34, s26, 16
 s_lshl_b32 s35, s32, 15
 s_add_u32 s34, s34, s35
 s_lshl_b32 s35, s27, 7
 s_add_u32 s34, s34, s35
 s_lshl_b32 s35, s33, 6
 s_add_u32 s34, s34, s35
 s_mov_b32 s8, s64
 s_and_b32 s9, s65, 0xffff
 s_mov_b32 s10, 0x200000
 s_mov_b32 s11, 0x20000
 buffer_load_dwordx2 v[48:49], v9, s[8:11], s34 offen offset:0
 buffer_load_dwordx2 v[50:51], v9, s[8:11], s34 offen offset:16
 buffer_load_dwordx2 v[52:53], v9, s[8:11], s34 offen offset:32
 buffer_load_dwordx2 v[54:55], v9, s[8:11], s34 offen offset:48
 s_lshl_b32 s35, s26, 16
 s_lshl_b32 s36, s20, 11
 s_add_u32 s35, s35, s36
 s_add_u32 s35, s35, 0x200000
 s_add_u32 s36, s36, 65536
 s_cmp_eq_u32 s20, 0
 s_cbranch_scc1 BK29
 s_branch PD32
BK29:
 s_lshl_b32 s58, s31, 11
 s_add_u32 s58, s58, 0xfb0000
 v_min_u32 v2, 15, v1
 v_lshlrev_b32 v2, 7, v2
 s_mov_b32 s59, 262144
PL31:
 buffer_load_dword v3, v2, s[4:7], s58 offen sc1
 s_waitcnt vmcnt(0)
 v_cmp_ne_u32 vcc, s60, v3
 s_cbranch_vccz PD32
 s_sleep 2
 s_sub_u32 s59, s59, 1
 s_cmp_lg_u32 s59, 0
 s_cbranch_scc1 PL31
PD32:
 s_barrier
 s_add_u32 s37, s35, 0
 s_add_u32 m0, s36, 0
 s_nop 0
 buffer_load_dwordx4 v4, s[4:7], s37 offen sc1 lds
 buffer_load_dwordx4 v4, s[4:7], s37 offen offset:1024 sc1 lds
 s_add_u32 s37, s35, 32768
 s_add_u32 m0, s36, 32768
 s_nop 0
 buffer_load_dwordx4 v4, s[4:7], s37 offen sc1 lds
 buffer_load_dwordx4 v4, s[4:7], s37 offen offset:1024 sc1 lds
 s_add_u32 s37, s35, 8192
 s_add_u32 m0, s36, 8192
 s_nop 0
 buffer_load_dwordx4 v4, s[4:7], s37 offen sc1 lds
 buffer_load_dwordx4 v4, s[4:7], s37 offen offset:1024 sc1 lds
 s_add_u32 s37, s35, 40960
 s_add_u32 m0, s36, 40960
 s_nop 0
 buffer_load_dwordx4 v4, s[4:7], s37 offen sc1 lds
 buffer_load_dwordx4 v4, s[4:7], s37 offen offset:1024 sc1 lds
 s_add_u32 s37, s35, 16384
 s_add_u32 m0, s36, 16384
 s_nop 0
 buffer_load_dwordx4 v4, s[4:7], s37 offen sc1 lds
 buffer_load_dwordx4 v4, s[4:7], s37 offen offset:1024 sc1 lds
 s_add_u32 s37, s35, 49152
 s_add_u32 m0, s36, 49152
 s_nop 0
 buffer_load_dwordx4 v4, s[4:7], s37 offen sc1 lds
 buffer_load_dwordx4 v4, s[4:7], s37 offen offset:1024 sc1 lds
 s_add_u32 s37, s35, 24576
 s_add_u32 m0, s36, 24576
 s_nop 0
 buffer_load_dwordx4 v4, s[4:7], s37 offen sc1 lds
 buffer_load_dwordx4 v4, s[4:7], s37 offen offset:1024 sc1 lds
 s_add_u32 s37, s35, 57344
 s_add_u32 m0, s36, 57344
 s_nop 0
 buffer_load_dwordx4 v4, s[4:7], s37 offen sc1 lds
 buffer_load_dwordx4 v4, s[4:7], s37 offen offset:1024 sc1 lds
 s_waitcnt vmcnt(12)
 s_barrier
 ds_read_b64_tr_b16 v[192:193], v6 offset:0
 ds_read_b64_tr_b16 v[194:195], v6 offset:1024
 ds_read_b128 v[224:227], v7 offset:0
 ds_read_b64_tr_b16 v[196:197], v6 offset:2048
 ds_read_b64_tr_b16 v[198:199], v6 offset:3072
 ds_read_b128 v[228:231], v7 offset:1024
 ds_read_b64_tr_b16 v[200:201], v6 offset:4096
 ds_read_b64_tr_b16 v[202:203], v6 offset:5120
 ds_read_b128 v[232:235], v7 offset:2048
 s_waitcnt lgkmcnt(6)
 v_mfma_f32_32x32x16_bf16 v[16:31], v[192:195], v[224:227], 0
 ds_read_b64_tr_b16 v[204:205], v6 offset:6144
 ds_read_b64_tr_b16 v[206:207], v6 offset:7168
 ds_read_b128 v[236:239], v7 offset:3072
 s_waitcnt lgkmcnt(6)
 v_mfma_f32_32x32x16_bf16 v[16:31], v[196:199], v[228:231], v[16:31]
 ds_read_b64_tr_b16 v[208:209], v6 offset:8192
 ds_read_b64_tr_b16 v[210:211], v6 offset:9216
 ds_read_b128 v[224:227], v7 offset:4096
 s_waitcnt lgkmcnt(6)
 v_mfma_f32_32x32x16_bf16 v[16:31], v[200:203], v[232:235], v[16:31]
 ds_read_b64_tr_b16 v[212:213], v6 offset:10240
 ds_read_b64_tr_b16 v[214:215], v6 offset:11264
 ds_read_b128 v[228:231], v7 offset:5120
 s_waitcnt lgkmcnt(6)
 v_mfma_f32_32x32x16_bf16 v[16:31], v[204:207], v[236:239], v[16:31]
 ds_read_b64_tr_b16 v[192:193], v6 offset:12288
 ds_read_b64_tr_b16 v[194:195], v6 offset:13312
 ds_read_b128 v[232:235], v7 offset:6144
 s_waitcnt lgkmcnt(6)
 v_mfma_f32_32x32x16_bf16 v[16:31], v[208:211], v[224:227], v[16:31]
 ds_read_b64_tr_b16 v[196:197], v6 offset:14336
 ds_read_b64_tr_b16 v[198:199], v6 offset:15360
 ds_read_b128 v[236:239], v7 offset:7168
 s_waitcnt lgkmcnt(6)
 v_mfma_f32_32x32x16_bf16 v[16:31], v[212:215], v[228:231], v[16:31]
 s_waitcnt vmcnt(8)
 s_barrier
 ds_read_b64_tr_b16 v[200:201], v6 offset:16384
 ds_read_b64_tr_b16 v[202:203], v6 offset:17408
 ds_read_b128 v[224:227], v7 offset:8192
 s_waitcnt lgkmcnt(6)
 v_mfma_f32_32x32x16_bf16 v[16:31], v[192:195], v[232:235], v[16:31]
 ds_read_b64_tr_b16 v[204:205], v6 offset:18432
 ds_read_b64_tr_b16 v[206:207], v6 offset:19456
 ds_read_b128 v[228:231], v7 offset:9216
 s_waitcnt lgkmcnt(6)
 v_mfma_f32_32x32x16_bf16 v[16:31], v[196:199], v[236:239], v[16:31]
 ds_read_b64_tr_b16 v[208:209], v6 offset:20480
 ds_read_b64_tr_b16 v[210:211], v6 offset:21504
 ds_read_b128 v[232:235], v7 offset:10240
 s_waitcnt lgkmcnt(6)
 v_mfma_f32_32x32x16_bf16 v[16:31], v[200:203], v[224:227], v[16:31]
 ds_read_b64_tr_b16 v[212:213], v6 offset:22528
 ds_read_b64_tr_b16 v[214:215], v6 offset:23552
 ds_read_b128 v[236:239], v7 offset:11264
 s_waitcnt lgkmcnt(6)
 v_mfma_f32_32x32x16_bf16 v[16:31], v[204:207], v[228:231], v[16:31]
 ds_read_b64_tr_b16 v[192:193], v6 offset:24576
 ds_read_b64_tr_b16 v[194:195], v6 offset:25600
 ds_read_b128 v[224:227], v7 offset:12288
 s_waitcnt lgkmcnt(6)
 v_mfma_f32_32x32x16_bf16 v[16:31], v[208:211], v[232:235], v[16:31]
 ds_read_b64_tr_b16 v[196:197], v6 offset:26624
 ds_read_b64_tr_b16 v[198:199], v6 offset:27648
 ds_read_b128 v[228:231], v7 offset:13312
 s_waitcnt lgkmcnt(6)
 v_mfma_f32_32x32x16_bf16 v[16:31], v[212:215], v[236:239], v[16:31]
 ds_read_b64_tr_b16 v[200:201], v6 offset:28672
 ds_read_b64_tr_b16 v[202:203], v6 offset:29696
 ds_read_b128 v[232:235], v7 offset:14336
 s_waitcnt lgkmcnt(6)
 v_mfma_f32_32x32x16_bf16 v[16:31], v[192:195], v[224:227], v[16:31]
 ds_read_b64_tr_b16 v[204:205], v6 offset:30720
 ds_read_b64_tr_b16 v[206:207], v6 offset:31744
 ds_read_b128 v[236:239], v7 offset:15360
 s_waitcnt lgkmcnt(6)
 v_mfma_f32_32x32x16_bf16 v[16:31], v[196:199], v[228:231], v[16:31]
 s_waitcnt vmcnt(4)
 s_barrier
 ds_read_b64_tr_b16 v[208:209], v6 offset:32768
 ds_read_b64_tr_b16 v[210:211], v6 offset:33792
 ds_read_b128 v[224:227], v7 offset:16384
 s_waitcnt lgkmcnt(6)
 v_mfma_f32_32x32x16_bf16 v[16:31], v[200:203], v[232:235], v[16:31]
 ds_read_b64_tr_b16 v[212:213], v6 offset:34816
 ds_read_b64_tr_b16 v[214:215], v6 offset:35840
 ds_read_b128 v[228:231], v7 offset:17408
 s_waitcnt lgkmcnt(6)
 v_mfma_f32_32x32x16_bf16 v[16:31], v[204:207], v[236:239], v[16:31]
 ds_read_b64_tr_b16 v[192:193], v6 offset:36864
 ds_read_b64_tr_b16 v[194:195], v6 offset:37888
 ds_read_b128 v[232:235], v7 offset:18432
 s_waitcnt lgkmcnt(6)
 v_mfma_f32_32x32x16_bf16 v[16:31], v[208:211], v[224:227], v[16:31]
 ds_read_b64_tr_b16 v[196:197], v6 offset:38912
 ds_read_b64_tr_b16 v[198:199], v6 offset:39936
 ds_read_b128 v[236:239], v7 offset:19456
 s_waitcnt lgkmcnt(6)
 v_mfma_f32_32x32x16_bf16 v[16:31], v[212:215], v[228:231], v[16:31]
 ds_read_b64_tr_b16 v[200:201], v6 offset:40960
 ds_read_b64_tr_b16 v[202:203], v6 offset:41984
 ds_read_b128 v[224:227], v7 offset:20480
 s_waitcnt lgkmcnt(6)
 v_mfma_f32_32x32x16_bf16 v[16:31], v[192:195], v[232:235], v[16:31]
 ds_read_b64_tr_b16 v[204:205], v6 offset:43008
 ds_read_b64_tr_b16 v[206:207], v6 offset:44032
 ds_read_b128 v[228:231], v7 offset:21504
 s_waitcnt lgkmcnt(6)
 v_mfma_f32_32x32x16_bf16 v[16:31], v[196:199], v[236:239], v[16:31]
 ds_read_b64_tr_b16 v[208:209], v6 offset:45056
 ds_read_b64_tr_b16 v[210:211], v6 offset:46080
 ds_read_b128 v[232:235], v7 offset:22528
 s_waitcnt lgkmcnt(6)
 v_mfma_f32_32x32x16_bf16 v[16:31], v[200:203], v[224:227], v[16:31]
 ds_read_b64_tr_b16 v[212:213], v6 offset:47104
 ds_read_b64_tr_b16 v[214:215], v6 offset:48128
 ds_read_b128 v[236:239], v7 offset:23552
 s_waitcnt lgkmcnt(6)
 v_mfma_f32_32x32x16_bf16 v[16:31], v[204:207], v[228:231], v[16:31]
 s_waitcnt vmcnt(0)
 s_barrier
 ds_read_b64_tr_b16 v[192:193], v6 offset:49152
 ds_read_b64_tr_b16 v[194:195], v6 offset:50176
 ds_read_b128 v[224:227], v7 offset:24576
 s_waitcnt lgkmcnt(6)
 v_mfma_f32_32x32x16_bf16 v[16:31], v[208:211], v[232:235], v[16:31]
 ds_read_b64_tr_b16 v[196:197], v6 offset:51200
 ds_read_b64_tr_b16 v[198:199], v6 offset:52224
 ds_read_b128 v[228:231], v7 offset:25600
 s_waitcnt lgkmcnt(6)
 v_mfma_f32_32x32x16_bf16 v[16:31], v[212:215], v[236:239], v[16:31]
 ds_read_b64_tr_b16 v[200:201], v6 offset:53248
 ds_read_b64_tr_b16 v[202:203], v6 offset:54272
 ds_read_b128 v[232:235], v7 offset:26624
 s_waitcnt lgkmcnt(6)
 v_mfma_f32_32x32x16_bf16 v[16:31], v[192:195], v[224:227], v[16:31]
 ds_read_b64_tr_b16 v[204:205], v6 offset:55296
 ds_read_b64_tr_b16 v[206:207], v6 offset:56320
 ds_read_b128 v[236:239], v7 offset:27648
 s_waitcnt lgkmcnt(6)
 v_mfma_f32_32x32x16_bf16 v[16:31], v[196:199], v[228:231], v[16:31]
 ds_read_b64_tr_b16 v[208:209], v6 offset:57344
 ds_read_b64_tr_b16 v[210:211], v6 offset:58368
 ds_read_b128 v[224:227], v7 offset:28672
 s_waitcnt lgkmcnt(6)
 v_mfma_f32_32x32x16_bf16 v[16:31], v[200:203], v[232:235], v[16:31]
 ds_read_b64_tr_b16 v[212:213], v6 offset:59392
 ds_read_b64_tr_b16 v[214:215], v6 offset:60416
 ds_read_b128 v[228:231], v7 offset:29696
 s_waitcnt lgkmcnt(6)
 v_mfma_f32_32x32x16_bf16 v[16:31], v[204:207], v[236:239], v[16:31]
 ds_read_b64_tr_b16 v[192:193], v6 offset:61440
 ds_read_b64_tr_b16 v[194:195], v6 offset:62464
 ds_read_b128 v[232:235], v7 offset:30720
 s_waitcnt lgkmcnt(6)
 v_mfma_f32_32x32x16_bf16 v[16:31], v[208:211], v[224:227], v[16:31]
 ds_read_b64_tr_b16 v[196:197], v6 offset:63488
 ds_read_b64_tr_b16 v[198:199], v6 offset:64512
 ds_read_b128 v[236:239], v7 offset:31744
 s_waitcnt lgkmcnt(6)
 v_mfma_f32_32x32x16_bf16 v[16:31], v[212:215], v[228:231], v[16:31]
 s_waitcnt lgkmcnt(3)
 v_mfma_f32_32x32x16_bf16 v[16:31], v[192:195], v[232:235], v[16:31]
 s_waitcnt lgkmcnt(0)
 v_mfma_f32_32x32x16_bf16 v[16:31], v[196:199], v[236:239], v[16:31]
 s_barrier
 s_lshl_b32 s34, s26, 1
 s_add_u32 s34, s34, s32
 s_lshl_b32 s35, s34, 5
 s_lshl_b32 s36, s27, 2
 s_add_u32 s35, s35, s36
 s_lshl_b32 s36, s33, 1
 s_add_u32 s35, s35, s36
 s_lshl_b32 s35, s35, 10
 s_add_u32 s35, s35, 0x500000
 s_lshl_b32 s36, s34, 4
 s_lshl_b32 s37, s27, 1
 s_add_u32 s36, s36, s37
 s_add_u32 s36, s36, s33
 s_lshl_b32 s36, s36, 8
 s_add_u32 s36, s36, 0x700000
 v_lshlrev_b32 v64, 16, v48
 v_and_b32 v65, 0xffff0000, v48
 v_lshlrev_b32 v66, 16, v49
 v_and_b32 v67, 0xffff0000, v49
 v_lshlrev_b32 v68, 16, v50
 v_and_b32 v69, 0xffff0000, v50
 v_lshlrev_b32 v70, 16, v51
 v_and_b32 v71, 0xffff0000, v51
 v_lshlrev_b32 v72, 16, v52
 v_and_b32 v73, 0xffff0000, v52
 v_lshlrev_b32 v74, 16, v53
 v_and_b32 v75, 0xffff0000, v53
 v_lshlrev_b32 v76, 16, v54
 v_and_b32 v77, 0xffff0000, v54
 v_lshlrev_b32 v78, 16, v55
 v_and_b32 v79, 0xffff0000, v55
 v_pk_add_f32 v[16:17], v[16:17], v[64:65]
 v_pk_add_f32 v[18:19], v[18:19], v[66:67]
 v_pk_add_f32 v[20:21], v[20:21], v[68:69]
 v_pk_add_f32 v[22:23], v[22:23], v[70:71]
 v_pk_add_f32 v[24:25], v[24:25], v[72:73]
 v_pk_add_f32 v[26:27], v[26:27], v[74:75]
 v_pk_add_f32 v[28:29], v[28:29], v[76:77]
 v_pk_add_f32 v[30:31], v[30:31], v[78:79]
 v_cvt_pk_bf16_f32 v180, v16, v17
 v_cvt_pk_bf16_f32 v181, v18, v19
 v_cvt_pk_bf16_f32 v182, v20, v21
 v_cvt_pk_bf16_f32 v183, v22, v23
 v_cvt_pk_bf16_f32 v184, v24, v25
 v_cvt_pk_bf16_f32 v185, v26, v27
 v_cvt_pk_bf16_f32 v186, v28, v29
 v_cvt_pk_bf16_f32 v187, v30, v31
 buffer_store_dwordx4 v[180:183], v4, s[4:7], s35 offen offset:0 sc1
 buffer_store_dwordx4 v[184:187], v4, s[4:7], s35 offen offset:1024 sc1
 v_lshlrev_b32 v64, 16, v180
 v_and_b32 v65, 0xffff0000, v180
 v_lshlrev_b32 v66, 16, v181
 v_and_b32 v67, 0xffff0000, v181
 v_lshlrev_b32 v68, 16, v182
 v_and_b32 v69, 0xffff0000, v182
 v_lshlrev_b32 v70, 16, v183
 v_and_b32 v71, 0xffff0000, v183
 v_lshlrev_b32 v72, 16, v184
 v_and_b32 v73, 0xffff0000, v184
 v_lshlrev_b32 v74, 16, v185
 v_and_b32 v75, 0xffff0000, v185
 v_lshlrev_b32 v76, 16, v186
 v_and_b32 v77, 0xffff0000, v186
 v_lshlrev_b32 v78, 16, v187
 v_and_b32 v79, 0xffff0000, v187
 v_pk_add_f32 v[80:81], v[64:65], v[66:67]
 v_pk_add_f32 v[82:83], v[68:69], v[70:71]
 v_pk_add_f32 v[84:85], v[72:73], v[74:75]
 v_pk_add_f32 v[86:87], v[76:77], v[78:79]
 v_pk_add_f32 v[80:81], v[80:81], v[82:83]
 v_pk_add_f32 v[84:85], v[84:85], v[86:87]
 v_pk_add_f32 v[80:81], v[80:81], v[84:85]
 v_add_f32 v88, v80, v81
 v_mov_b32 v89, v88
 s_nop 1
 v_permlane32_swap_b32 v88, v89
 v_add_f32 v88, v88, v89
 v_mul_f32 v88, 0x3d000000, v88
 v_sub_f32 v90, 0, v88
 v_pk_add_f32 v[64:65], v[64:65], v[90:91] op_sel_hi:[1,0]
 v_pk_add_f32 v[66:67], v[66:67], v[90:91] op_sel_hi:[1,0]
 v_pk_add_f32 v[68:69], v[68:69], v[90:91] op_sel_hi:[1,0]
 v_pk_add_f32 v[70:71], v[70:71], v[90:91] op_sel_hi:[1,0]
 v_pk_add_f32 v[72:73], v[72:73], v[90:91] op_sel_hi:[1,0]
 v_pk_add_f32 v[74:75], v[74:75], v[90:91] op_sel_hi:[1,0]
 v_pk_add_f32 v[76:77], v[76:77], v[90:91] op_sel_hi:[1,0]
 v_pk_add_f32 v[78:79], v[78:79], v[90:91] op_sel_hi:[1,0]
 v_pk_mul_f32 v[80:81], v[64:65], v[64:65]
 v_pk_mul_f32 v[82:83], v[66:67], v[66:67]
 v_pk_fma_f32 v[80:81], v[68:69], v[68:69], v[80:81]
 v_pk_fma_f32 v[82:83], v[70:71], v[70:71], v[82:83]
 v_pk_fma_f32 v[80:81], v[72:73], v[72:73], v[80:81]
 v_pk_fma_f32 v[82:83], v[74:75], v[74:75], v[82:83]
 v_pk_fma_f32 v[80:81], v[76:77], v[76:77], v[80:81]
 v_pk_fma_f32 v[82:83], v[78:79], v[78:79], v[82:83]
 v_pk_add_f32 v[80:81], v[80:81], v[82:83]
 v_add_f32 v89, v80, v81
 v_mov_b32 v90, v89
 s_nop 1
 v_permlane32_swap_b32 v89, v90
 v_add_f32 v89, v89, v90
 v_lshlrev_b32 v10, 3, v1
 s_mov_b32 exec_hi, 0
 buffer_store_dwordx2 v[88:89], v10, s[4:7], s36 offen sc1
 s_mov_b64 exec, -1
 s_cmp_lg_u32 s20, 0
 s_cbranch_scc1 PD35
 s_mul_i32 s35, s29, 7
 s_lshr_b32 s35, s35, 2
 s_lshl_b32 s35, s35, 3
 v_min_u32 v2, 23, v1
 v_add_u32 v2, s35, v2
 v_min_u32 v2, 223, v2
 v_lshlrev_b32 v2, 2, v2
 s_mov_b32 s58, 0xf25000
 s_mov_b32 s59, 262144
 s_mov_b32 s55, 0xf26000
 v_lshlrev_b32 v18, 2, v1
 v_add_u32 v16, 64, v1
 v_min_u32 v16, 111, v16
 v_lshlrev_b32 v16, 2, v16
PL34:
 buffer_load_dword v3, v2, s[4:7], s58 offen sc1
 buffer_load_dword v19, v18, s[4:7], s55 offen sc1
 buffer_load_dword v17, v16, s[4:7], s55 offen sc1
 s_waitcnt vmcnt(0)
 v_cmp_ne_u32 vcc, s60, v3
 v_cmp_ne_u32 s[56:57], s60, v19
 s_nop 1
 s_or_b64 vcc, vcc, s[56:57]
 v_cmp_ne_u32 s[56:57], s60, v17
 s_nop 1
 s_or_b64 vcc, vcc, s[56:57]
 s_cbranch_vccz PD35
 s_sleep 2
 s_sub_u32 s59, s59, 1
 s_cmp_lg_u32 s59, 0
 s_cbranch_scc1 PL34
PD35:
 s_waitcnt vmcnt(0)
 s_and_b32 s35, s26, 1
 s_lshl_b32 s35, s35, 3
 s_add_u32 s35, s35, s27
 s_barrier
 s_cmp_lg_u32 s20, 0
 s_cbranch_scc1 AR36
 s_lshl_b32 s58, s31, 4
 s_add_u32 s58, s58, s35
 s_lshl_b32 s58, s58, 7
 s_add_u32 s58, s58, 0xfb8000
 v_mov_b32 v2, s60
 v_mov_b32 v3, 0
 s_mov_b64 exec, 1
 buffer_store_dword v2, v3, s[4:7], s58 offen sc1
 s_mov_b64 exec, -1
AR36:
 s_or_b32 s35, s2, s20
 s_cmp_lg_u32 s35, 3
 s_cbranch_scc1 EP37
 s_cmp_lg_u32 s2, 0
 s_cbranch_scc1 EP37
 s_mov_b32 s36, 0xf30000
 s_load_dword s35, s[84:85], s36
 s_waitcnt lgkmcnt(0)
 s_add_u32 s35, s35, 1
 v_mov_b32 v2, s35
 v_mov_b32 v3, 0
 s_mov_b64 exec, 1
 buffer_store_dword v2, v3, s[4:7], s36 offen sc1
 s_mov_b64 exec, -1
EP37:
 s_lshl_b32 s31, s28, 2
 s_add_u32 s31, s31, s20
 v_add_u32 v5, 0x10000, v4
 v_add_u32 v6, 0x20000, v4
 s_mul_i32 s44, s29, 229376
 s_lshl_b32 s45, s20, 12
 s_add_u32 s44, s44, s45
 s_add_u32 s44, s44, 0x1000000
 s_lshl_b32 s33, s31, 12
 s_add_u32 s33, s33, 0x700000
 v_and_b32 v15, 31, v1
 v_lshlrev_b32 v15, 3, v15
 v_lshrrev_b32 v14, 5, v1
 v_lshlrev_b32 v14, 11, v14
 v_add_u32 v15, v15, v14
 s_lshl_b32 s34, s31, 15
 s_add_u32 s34, s34, 0x500000
 s_mul_i32 s36, s31, 114688
 s_mul_i32 s37, s29, 7168
 s_add_u32 s36, s36, s37
 s_add_u32 s36, s36, 0x800000
 s_add_u32 s46, s44, 0
 s_add_u32 m0, s45, 0
 s_nop 0
 buffer_load_dwordx4 v4, s[4:7], s46 offen sc1 lds
 buffer_load_dwordx4 v4, s[4:7], s46 offen offset:1024 sc1 lds
 buffer_load_dwordx4 v4, s[4:7], s46 offen offset:2048 sc1 lds
 buffer_load_dwordx4 v4, s[4:7], s46 offen offset:3072 sc1 lds
 s_add_u32 s46, s44, 32768
 s_add_u32 m0, s45, 16384
 s_nop 0
 buffer_load_dwordx4 v4, s[4:7], s46 offen sc1 lds
 buffer_load_dwordx4 v4, s[4:7], s46 offen offset:1024 sc1 lds
 buffer_load_dwordx4 v4, s[4:7], s46 offen offset:2048 sc1 lds
 buffer_load_dwordx4 v4, s[4:7], s46 offen offset:3072 sc1 lds
 s_add_u32 s46, s44, 65536
 s_add_u32 m0, s45, 32768
 s_nop 0
 buffer_load_dwordx4 v4, s[4:7], s46 offen sc1 lds
 buffer_load_dwordx4 v4, s[4:7], s46 offen offset:1024 sc1 lds
 buffer_load_dwordx4 v4, s[4:7], s46 offen offset:2048 sc1 lds
 buffer_load_dwordx4 v4, s[4:7], s46 offen offset:3072 sc1 lds
 s_add_u32 s46, s44, 98304
 s_add_u32 m0, s45, 49152
 s_nop 0
 buffer_load_dwordx4 v4, s[4:7], s46 offen sc1 lds
 buffer_load_dwordx4 v4, s[4:7], s46 offen offset:1024 sc1 lds
 buffer_load_dwordx4 v4, s[4:7], s46 offen offset:2048 sc1 lds
 buffer_load_dwordx4 v4, s[4:7], s46 offen offset:3072 sc1 lds
 s_add_u32 s46, s44, 16384
 s_add_u32 m0, s45, 65536
 s_nop 0
 buffer_load_dwordx4 v4, s[4:7], s46 offen sc1 lds
 buffer_load_dwordx4 v4, s[4:7], s46 offen offset:1024 sc1 lds
 buffer_load_dwordx4 v4, s[4:7], s46 offen offset:2048 sc1 lds
 buffer_load_dwordx4 v4, s[4:7], s46 offen offset:3072 sc1 lds
 s_add_u32 s46, s44, 49152
 s_add_u32 m0, s45, 81920
 s_nop 0
 buffer_load_dwordx4 v4, s[4:7], s46 offen sc1 lds
 buffer_load_dwordx4 v4, s[4:7], s46 offen offset:1024 sc1 lds
 buffer_load_dwordx4 v4, s[4:7], s46 offen offset:2048 sc1 lds
 buffer_load_dwordx4 v4, s[4:7], s46 offen offset:3072 sc1 lds
 s_cmp_lg_u32 s20, 0
 s_cbranch_scc1 PD41
BK38:
 s_lshl_b32 s58, s28, 11
 s_add_u32 s58, s58, 0xfb8000
 v_min_u32 v2, 15, v1
 v_lshlrev_b32 v2, 7, v2
 s_mov_b32 s59, 262144
PL40:
 buffer_load_dword v3, v2, s[4:7], s58 offen sc1
 s_waitcnt vmcnt(0)
 v_cmp_ne_u32 vcc, s60, v3
 s_cbranch_vccz PD41
 s_sleep 2
 s_sub_u32 s59, s59, 1
 s_cmp_lg_u32 s59, 0
 s_cbranch_scc1 PL40
PD41:
 s_barrier
 s_add_u32 s35, s34, 0
 buffer_load_dwordx4 a[0:3], v4, s[4:7], s35 offen offset:0 sc1
 buffer_load_dwordx4 a[4:7], v4, s[4:7], s35 offen offset:1024 sc1
 buffer_load_dwordx4 a[8:11], v4, s[4:7], s35 offen offset:2048 sc1
 buffer_load_dwordx4 a[12:15], v4, s[4:7], s35 offen offset:3072 sc1
 s_add_u32 s35, s34, 4096
 buffer_load_dwordx4 a[16:19], v4, s[4:7], s35 offen offset:0 sc1
 buffer_load_dwordx4 a[20:23], v4, s[4:7], s35 offen offset:1024 sc1
 buffer_load_dwordx4 a[24:27], v4, s[4:7], s35 offen offset:2048 sc1
 buffer_load_dwordx4 a[28:31], v4, s[4:7], s35 offen offset:3072 sc1
 v_lshrrev_b32 v14, 5, v1
 v_mul_u32_u24 v14, 28672, v14
 v_and_b32 v13, 31, v1
 v_lshlrev_b32 v13, 2, v13
 v_add_u32 v14, v14, v13
 s_mul_i32 s32, s29, 896
 s_add_u32 s32, s32, 0xf00000
 s_add_u32 s37, s32, 14336
 s_waitcnt vmcnt(16)
 s_barrier
 ds_read_b128 v[192:195], v4 offset:0
 ds_read_b128 v[196:199], v4 offset:16384
 ds_read_b128 v[200:203], v4 offset:32768
 ds_read_b128 v[204:207], v4 offset:49152
 ds_read_b128 v[208:211], v4 offset:1024
 ds_read_b128 v[212:215], v4 offset:17408
 ds_read_b128 v[216:219], v4 offset:33792
 s_waitcnt vmcnt(7) lgkmcnt(3)
 v_mfma_f32_32x32x16_bf16 v[16:31], v[192:195], a[0:3], 0
 ds_read_b128 v[220:223], v4 offset:50176
 s_add_u32 s35, s34, 8192
 buffer_load_dwordx4 a[32:35], v4, s[4:7], s35 offen offset:0 sc1
 v_mfma_f32_32x32x16_bf16 v[32:47], v[196:199], a[0:3], 0
 ds_read_b128 v[192:195], v4 offset:2048
 buffer_load_dwordx2 v[96:97], v15, s[4:7], s33 offen offset:0 sc1
 v_mfma_f32_32x32x16_bf16 v[48:63], v[200:203], a[0:3], 0
 ds_read_b128 v[196:199], v4 offset:18432
 s_add_u32 s46, s44, 81920
 s_add_u32 m0, s45, 98304
 s_nop 0
 buffer_load_dwordx4 v4, s[4:7], s46 offen sc1 lds
 v_mfma_f32_32x32x16_bf16 v[64:79], v[204:207], a[0:3], 0
 ds_read_b128 v[200:203], v4 offset:34816
 buffer_load_dwordx2 v[98:99], v15, s[4:7], s33 offen offset:256 sc1
 s_waitcnt vmcnt(10) lgkmcnt(3)
 v_mfma_f32_32x32x16_bf16 v[16:31], v[208:211], a[4:7], v[16:31]
 ds_read_b128 v[204:207], v4 offset:51200
 buffer_load_dwordx4 a[36:39], v4, s[4:7], s35 offen offset:1024 sc1
 v_mfma_f32_32x32x16_bf16 v[32:47], v[212:215], a[4:7], v[32:47]
 ds_read_b128 v[208:211], v4 offset:3072
 buffer_load_dwordx2 v[100:101], v15, s[4:7], s33 offen offset:512 sc1
 v_mfma_f32_32x32x16_bf16 v[48:63], v[216:219], a[4:7], v[48:63]
 ds_read_b128 v[212:215], v4 offset:19456
 buffer_load_dwordx4 v4, s[4:7], s46 offen offset:1024 sc1 lds
 v_mfma_f32_32x32x16_bf16 v[64:79], v[220:223], a[4:7], v[64:79]
 ds_read_b128 v[216:219], v4 offset:35840
 buffer_load_dwordx2 v[102:103], v15, s[4:7], s33 offen offset:768 sc1
 s_waitcnt vmcnt(13) lgkmcnt(3)
 v_mfma_f32_32x32x16_bf16 v[16:31], v[192:195], a[8:11], v[16:31]
 ds_read_b128 v[220:223], v4 offset:52224
 buffer_load_dwordx4 a[40:43], v4, s[4:7], s35 offen offset:2048 sc1
 v_mfma_f32_32x32x16_bf16 v[32:47], v[196:199], a[8:11], v[32:47]
 ds_read_b128 v[192:195], v4 offset:4096
 buffer_load_dwordx2 v[104:105], v15, s[4:7], s33 offen offset:1024 sc1
 v_mfma_f32_32x32x16_bf16 v[48:63], v[200:203], a[8:11], v[48:63]
 ds_read_b128 v[196:199], v4 offset:20480
 buffer_load_dwordx4 v4, s[4:7], s46 offen offset:2048 sc1 lds
 v_mfma_f32_32x32x16_bf16 v[64:79], v[204:207], a[8:11], v[64:79]
 ds_read_b128 v[200:203], v4 offset:36864
 buffer_load_dwordx2 v[106:107], v15, s[4:7], s33 offen offset:1280 sc1
 s_waitcnt vmcnt(16) lgkmcnt(3)
 v_mfma_f32_32x32x16_bf16 v[16:31], v[208:211], a[12:15], v[16:31]
 ds_read_b128 v[204:207], v4 offset:53248
 buffer_load_dwordx4 a[44:47], v4, s[4:7], s35 offen offset:3072 sc1
 v_mfma_f32_32x32x16_bf16 v[32:47], v[212:215], a[12:15], v[32:47]
 ds_read_b128 v[208:211], v4 offset:5120
 buffer_load_dwordx2 v[108:109], v15, s[4:7], s33 offen offset:1536 sc1
 v_mfma_f32_32x32x16_bf16 v[48:63], v[216:219], a[12:15], v[48:63]
 ds_read_b128 v[212:215], v4 offset:21504
 buffer_load_dwordx4 v4, s[4:7], s46 offen offset:3072 sc1 lds
 v_mfma_f32_32x32x16_bf16 v[64:79], v[220:223], a[12:15], v[64:79]
 ds_read_b128 v[216:219], v4 offset:37888
 buffer_load_dwordx2 v[110:111], v15, s[4:7], s33 offen offset:1792 sc1
 s_waitcnt vmcnt(19) lgkmcnt(3)
 v_mfma_f32_32x32x16_bf16 v[16:31], v[192:195], a[16:19], v[16:31]
 ds_read_b128 v[220:223], v4 offset:54272
 s_add_u32 s35, s34, 12288
 buffer_load_dwordx4 a[48:51], v4, s[4:7], s35 offen offset:0 sc1
 v_mfma_f32_32x32x16_bf16 v[32:47], v[196:199], a[16:19], v[32:47]
 ds_read_b128 v[192:195], v4 offset:6144
 buffer_load_dword v128, v14, s[4:7], s32 offen offset:0 sc1
 v_mfma_f32_32x32x16_bf16 v[48:63], v[200:203], a[16:19], v[48:63]
 ds_read_b128 v[196:199], v4 offset:22528
 s_add_u32 s46, s44, 114688
 s_add_u32 m0, s45, 114688
 s_nop 0
 buffer_load_dwordx4 v4, s[4:7], s46 offen sc1 lds
 v_mfma_f32_32x32x16_bf16 v[64:79], v[204:207], a[16:19], v[64:79]
 ds_read_b128 v[200:203], v4 offset:38912
 buffer_load_dword v129, v14, s[4:7], s32 offen offset:128 sc1
 s_waitcnt vmcnt(22) lgkmcnt(3)
 v_mfma_f32_32x32x16_bf16 v[16:31], v[208:211], a[20:23], v[16:31]
 ds_read_b128 v[204:207], v4 offset:55296
 buffer_load_dwordx4 a[52:55], v4, s[4:7], s35 offen offset:1024 sc1
 v_mfma_f32_32x32x16_bf16 v[32:47], v[212:215], a[20:23], v[32:47]
 ds_read_b128 v[208:211], v4 offset:7168
 buffer_load_dword v130, v14, s[4:7], s32 offen offset:256 sc1
 v_mfma_f32_32x32x16_bf16 v[48:63], v[216:219], a[20:23], v[48:63]
 ds_read_b128 v[212:215], v4 offset:23552
 buffer_load_dwordx4 v4, s[4:7], s46 offen offset:1024 sc1 lds
 v_mfma_f32_32x32x16_bf16 v[64:79], v[220:223], a[20:23], v[64:79]
 ds_read_b128 v[216:219], v4 offset:39936
 buffer_load_dword v131, v14, s[4:7], s32 offen offset:384 sc1
 s_waitcnt vmcnt(25) lgkmcnt(3)
 v_mfma_f32_32x32x16_bf16 v[16:31], v[192:195], a[24:27], v[16:31]
 ds_read_b128 v[220:223], v4 offset:56320
 buffer_load_dwordx4 a[56:59], v4, s[4:7], s35 offen offset:2048 sc1
 v_mfma_f32_32x32x16_bf16 v[32:47], v[196:199], a[24:27], v[32:47]
 ds_read_b128 v[192:195], v4 offset:8192
 buffer_load_dword v132, v14, s[4:7], s32 offen offset:512 sc1
 v_mfma_f32_32x32x16_bf16 v[48:63], v[200:203], a[24:27], v[48:63]
 ds_read_b128 v[196:199], v4 offset:24576
 buffer_load_dwordx4 v4, s[4:7], s46 offen offset:2048 sc1 lds
 v_mfma_f32_32x32x16_bf16 v[64:79], v[204:207], a[24:27], v[64:79]
 ds_read_b128 v[200:203], v4 offset:40960
 buffer_load_dword v133, v14, s[4:7], s32 offen offset:640 sc1
 s_waitcnt vmcnt(28) lgkmcnt(3)
 v_mfma_f32_32x32x16_bf16 v[16:31], v[208:211], a[28:31], v[16:31]
 ds_read_b128 v[204:207], v4 offset:57344
 buffer_load_dwordx4 a[60:63], v4, s[4:7], s35 offen offset:3072 sc1
 v_mfma_f32_32x32x16_bf16 v[32:47], v[212:215], a[28:31], v[32:47]
 ds_read_b128 v[208:211], v4 offset:9216
 buffer_load_dword v134, v14, s[4:7], s32 offen offset:768 sc1
 v_mfma_f32_32x32x16_bf16 v[48:63], v[216:219], a[28:31], v[48:63]
 ds_read_b128 v[212:215], v4 offset:25600
 buffer_load_dwordx4 v4, s[4:7], s46 offen offset:3072 sc1 lds
 v_mfma_f32_32x32x16_bf16 v[64:79], v[220:223], a[28:31], v[64:79]
 ds_read_b128 v[216:219], v4 offset:41984
 buffer_load_dword v136, v14, s[4:7], s37 offen offset:0 sc1
 s_waitcnt vmcnt(31) lgkmcnt(3)
 v_mfma_f32_32x32x16_bf16 v[16:31], v[192:195], a[32:35], v[16:31]
 ds_read_b128 v[220:223], v4 offset:58368
 s_add_u32 s35, s34, 16384
 buffer_load_dwordx4 a[64:67], v4, s[4:7], s35 offen offset:0 sc1
 v_mfma_f32_32x32x16_bf16 v[32:47], v[196:199], a[32:35], v[32:47]
 ds_read_b128 v[192:195], v4 offset:10240
 buffer_load_dword v137, v14, s[4:7], s37 offen offset:128 sc1
 v_mfma_f32_32x32x16_bf16 v[48:63], v[200:203], a[32:35], v[48:63]
 ds_read_b128 v[196:199], v4 offset:26624
 v_mfma_f32_32x32x16_bf16 v[64:79], v[204:207], a[32:35], v[64:79]
 ds_read_b128 v[200:203], v4 offset:43008
 buffer_load_dword v138, v14, s[4:7], s37 offen offset:256 sc1
 s_waitcnt vmcnt(30) lgkmcnt(3)
 v_mfma_f32_32x32x16_bf16 v[16:31], v[208:211], a[36:39], v[16:31]
 ds_read_b128 v[204:207], v4 offset:59392
 buffer_load_dwordx4 a[68:71], v4, s[4:7], s35 offen offset:1024 sc1
 v_mfma_f32_32x32x16_bf16 v[32:47], v[212:215], a[36:39], v[32:47]
 ds_read_b128 v[208:211], v4 offset:11264
 buffer_load_dword v139, v14, s[4:7], s37 offen offset:384 sc1
 v_mfma_f32_32x32x16_bf16 v[48:63], v[216:219], a[36:39], v[48:63]
 ds_read_b128 v[212:215], v4 offset:27648
 v_mfma_f32_32x32x16_bf16 v[64:79], v[220:223], a[36:39], v[64:79]
 ds_read_b128 v[216:219], v4 offset:44032
 buffer_load_dword v140, v14, s[4:7], s37 offen offset:512 sc1
 s_waitcnt vmcnt(29) lgkmcnt(3)
 v_mfma_f32_32x32x16_bf16 v[16:31], v[192:195], a[40:43], v[16:31]
 ds_read_b128 v[220:223], v4 offset:60416
 buffer_load_dwordx4 a[72:75], v4, s[4:7], s35 offen offset:2048 sc1
 v_mfma_f32_32x32x16_bf16 v[32:47], v[196:199], a[40:43], v[32:47]
 ds_read_b128 v[192:195], v4 offset:12288
 buffer_load_dword v141, v14, s[4:7], s37 offen offset:640 sc1
 v_mfma_f32_32x32x16_bf16 v[48:63], v[200:203], a[40:43], v[48:63]
 ds_read_b128 v[196:199], v4 offset:28672
 v_mfma_f32_32x32x16_bf16 v[64:79], v[204:207], a[40:43], v[64:79]
 ds_read_b128 v[200:203], v4 offset:45056
 buffer_load_dword v142, v14, s[4:7], s37 offen offset:768 sc1
 s_waitcnt vmcnt(28) lgkmcnt(3)
 v_mfma_f32_32x32x16_bf16 v[16:31], v[208:211], a[44:47], v[16:31]
 ds_read_b128 v[204:207], v4 offset:61440
 buffer_load_dwordx4 a[76:79], v4, s[4:7], s35 offen offset:3072 sc1
 v_mfma_f32_32x32x16_bf16 v[32:47], v[212:215], a[44:47], v[32:47]
 ds_read_b128 v[208:211], v4 offset:13312
 v_mfma_f32_32x32x16_bf16 v[48:63], v[216:219], a[44:47], v[48:63]
 ds_read_b128 v[212:215], v4 offset:29696
 v_mfma_f32_32x32x16_bf16 v[64:79], v[220:223], a[44:47], v[64:79]
 ds_read_b128 v[216:219], v4 offset:46080
 s_waitcnt vmcnt(25) lgkmcnt(3)
 v_mfma_f32_32x32x16_bf16 v[16:31], v[192:195], a[48:51], v[16:31]
 ds_read_b128 v[220:223], v4 offset:62464
 s_add_u32 s35, s34, 20480
 buffer_load_dwordx4 a[80:83], v4, s[4:7], s35 offen offset:0 sc1
 v_mfma_f32_32x32x16_bf16 v[32:47], v[196:199], a[48:51], v[32:47]
 ds_read_b128 v[192:195], v4 offset:14336
 v_mfma_f32_32x32x16_bf16 v[48:63], v[200:203], a[48:51], v[48:63]
 ds_read_b128 v[196:199], v4 offset:30720
 v_mfma_f32_32x32x16_bf16 v[64:79], v[204:207], a[48:51], v[64:79]
 ds_read_b128 v[200:203], v4 offset:47104
 s_waitcnt vmcnt(22) lgkmcnt(3)
 v_mfma_f32_32x32x16_bf16 v[16:31], v[208:211], a[52:55], v[16:31]
 ds_read_b128 v[204:207], v4 offset:63488
 buffer_load_dwordx4 a[84:87], v4, s[4:7], s35 offen offset:1024 sc1
 v_mfma_f32_32x32x16_bf16 v[32:47], v[212:215], a[52:55], v[32:47]
 ds_read_b128 v[208:211], v4 offset:15360
 v_mfma_f32_32x32x16_bf16 v[48:63], v[216:219], a[52:55], v[48:63]
 ds_read_b128 v[212:215], v4 offset:31744
 v_mfma_f32_32x32x16_bf16 v[64:79], v[220:223], a[52:55], v[64:79]
 ds_read_b128 v[216:219], v4 offset:48128
 s_waitcnt vmcnt(19) lgkmcnt(3)
 v_mfma_f32_32x32x16_bf16 v[16:31], v[192:195], a[56:59], v[16:31]
 ds_read_b128 v[220:223], v4 offset:64512
 buffer_load_dwordx4 a[88:91], v4, s[4:7], s35 offen offset:2048 sc1
 v_mfma_f32_32x32x16_bf16 v[32:47], v[196:199], a[56:59], v[32:47]
 s_waitcnt vmcnt(14)
 s_barrier
 ds_read_b128 v[192:195], v5 offset:0
 v_mfma_f32_32x32x16_bf16 v[48:63], v[200:203], a[56:59], v[48:63]
 ds_read_b128 v[196:199], v5 offset:16384
 v_mfma_f32_32x32x16_bf16 v[64:79], v[204:207], a[56:59], v[64:79]
 ds_read_b128 v[200:203], v5 offset:32768
 s_waitcnt lgkmcnt(3)
 v_mfma_f32_32x32x16_bf16 v[16:31], v[208:211], a[60:63], v[16:31]
 ds_read_b128 v[204:207], v5 offset:49152
 buffer_load_dwordx4 a[92:95], v4, s[4:7], s35 offen offset:3072 sc1
 v_mfma_f32_32x32x16_bf16 v[32:47], v[212:215], a[60:63], v[32:47]
 ds_read_b128 v[208:211], v5 offset:1024
 v_mfma_f32_32x32x16_bf16 v[48:63], v[216:219], a[60:63], v[48:63]
 ds_read_b128 v[212:215], v5 offset:17408
 v_mfma_f32_32x32x16_bf16 v[64:79], v[220:223], a[60:63], v[64:79]
 ds_read_b128 v[216:219], v5 offset:33792
 s_waitcnt vmcnt(13) lgkmcnt(3)
 v_mfma_f32_32x32x16_bf16 v[16:31], v[192:195], a[64:67], v[16:31]
 ds_read_b128 v[220:223], v5 offset:50176
 s_add_u32 s35, s34, 24576
 buffer_load_dwordx4 a[96:99], v4, s[4:7], s35 offen offset:0 sc1
 v_mfma_f32_32x32x16_bf16 v[32:47], v[196:199], a[64:67], v[32:47]
 ds_read_b128 v[192:195], v5 offset:2048
 v_mfma_f32_32x32x16_bf16 v[48:63], v[200:203], a[64:67], v[48:63]
 ds_read_b128 v[196:199], v5 offset:18432
 v_mfma_f32_32x32x16_bf16 v[64:79], v[204:207], a[64:67], v[64:79]
 ds_read_b128 v[200:203], v5 offset:34816
 s_waitcnt vmcnt(11) lgkmcnt(3)
 v_mfma_f32_32x32x16_bf16 v[16:31], v[208:211], a[68:71], v[16:31]
 ds_read_b128 v[204:207], v5 offset:51200
 buffer_load_dwordx4 a[100:103], v4, s[4:7], s35 offen offset:1024 sc1
 v_mfma_f32_32x32x16_bf16 v[32:47], v[212:215], a[68:71], v[32:47]
 ds_read_b128 v[208:211], v5 offset:3072
 v_mfma_f32_32x32x16_bf16 v[48:63], v[216:219], a[68:71], v[48:63]
 ds_read_b128 v[212:215], v5 offset:19456
 v_mfma_f32_32x32x16_bf16 v[64:79], v[220:223], a[68:71], v[64:79]
 ds_read_b128 v[216:219], v5 offset:35840
 s_waitcnt vmcnt(9) lgkmcnt(3)
 v_mfma_f32_32x32x16_bf16 v[16:31], v[192:195], a[72:75], v[16:31]
 ds_read_b128 v[220:223], v5 offset:52224
 buffer_load_dwordx4 a[104:107], v4, s[4:7], s35 offen offset:2048 sc1
 v_mfma_f32_32x32x16_bf16 v[32:47], v[196:199], a[72:75], v[32:47]
 ds_read_b128 v[192:195], v5 offset:4096
 v_mfma_f32_32x32x16_bf16 v[48:63], v[200:203], a[72:75], v[48:63]
 ds_read_b128 v[196:199], v5 offset:20480
 v_mfma_f32_32x32x16_bf16 v[64:79], v[204:207], a[72:75], v[64:79]
 ds_read_b128 v[200:203], v5 offset:36864
 s_waitcnt vmcnt(7) lgkmcnt(3)
 v_mfma_f32_32x32x16_bf16 v[16:31], v[208:211], a[76:79], v[16:31]
 ds_read_b128 v[204:207], v5 offset:53248
 buffer_load_dwordx4 a[108:111], v4, s[4:7], s35 offen offset:3072 sc1
 v_mfma_f32_32x32x16_bf16 v[32:47], v[212:215], a[76:79], v[32:47]
 ds_read_b128 v[208:211], v5 offset:5120
 v_mfma_f32_32x32x16_bf16 v[48:63], v[216:219], a[76:79], v[48:63]
 ds_read_b128 v[212:215], v5 offset:21504
 v_mfma_f32_32x32x16_bf16 v[64:79], v[220:223], a[76:79], v[64:79]
 ds_read_b128 v[216:219], v5 offset:37888
 s_waitcnt vmcnt(7) lgkmcnt(3)
 v_mfma_f32_32x32x16_bf16 v[16:31], v[192:195], a[80:83], v[16:31]
 ds_read_b128 v[220:223], v5 offset:54272
 s_add_u32 s35, s34, 28672
 buffer_load_dwordx4 a[112:115], v4, s[4:7], s35 offen offset:0 sc1
 v_cmp_gt_u32 vcc, 32, v1
 v_add_f32 v128, v128, v136
 v_add_f32 v129, v129, v137
 v_mfma_f32_32x32x16_bf16 v[32:47], v[196:199], a[80:83], v[32:47]
 ds_read_b128 v[192:195], v5 offset:6144
 v_add_f32 v130, v130, v138
 v_add_f32 v131, v131, v139
 v_add_f32 v132, v132, v140
 v_mfma_f32_32x32x16_bf16 v[48:63], v[200:203], a[80:83], v[48:63]
 ds_read_b128 v[196:199], v5 offset:22528
 v_add_f32 v133, v133, v141
 v_add_f32 v134, v134, v142
 v_mov_b32 v136, v128
 v_mfma_f32_32x32x16_bf16 v[64:79], v[204:207], a[80:83], v[64:79]
 ds_read_b128 v[200:203], v5 offset:38912
 v_mov_b32 v137, v129
 v_mov_b32 v138, v130
 v_mov_b32 v139, v131
 s_waitcnt vmcnt(7) lgkmcnt(3)
 v_mfma_f32_32x32x16_bf16 v[16:31], v[208:211], a[84:87], v[16:31]
 ds_read_b128 v[204:207], v5 offset:55296
 buffer_load_dwordx4 a[116:119], v4, s[4:7], s35 offen offset:1024 sc1
 v_mov_b32 v140, v132
 v_mov_b32 v141, v133
 v_mov_b32 v142, v134
 v_mfma_f32_32x32x16_bf16 v[32:47], v[212:215], a[84:87], v[32:47]
 ds_read_b128 v[208:211], v5 offset:7168
 v_permlane32_swap_b32 v128, v136
 v_permlane32_swap_b32 v129, v137
 v_permlane32_swap_b32 v130, v138
 v_mfma_f32_32x32x16_bf16 v[48:63], v[216:219], a[84:87], v[48:63]
 ds_read_b128 v[212:215], v5 offset:23552
 v_permlane32_swap_b32 v131, v139
 v_permlane32_swap_b32 v132, v140
 v_permlane32_swap_b32 v133, v141
 v_mfma_f32_32x32x16_bf16 v[64:79], v[220:223], a[84:87], v[64:79]
 ds_read_b128 v[216:219], v5 offset:39936
 v_permlane32_swap_b32 v134, v142
 v_add_f32 v128, v128, v136
 v_add_f32 v129, v129, v137
 s_waitcnt vmcnt(7) lgkmcnt(3)
 v_mfma_f32_32x32x16_bf16 v[16:31], v[192:195], a[88:91], v[16:31]
 ds_read_b128 v[220:223], v5 offset:56320
 buffer_load_dwordx4 a[120:123], v4, s[4:7], s35 offen offset:2048 sc1
 v_add_f32 v130, v130, v138
 v_add_f32 v131, v131, v139
 v_add_f32 v132, v132, v140
 v_mfma_f32_32x32x16_bf16 v[32:47], v[196:199], a[88:91], v[32:47]
 ds_read_b128 v[192:195], v5 offset:8192
 v_add_f32 v133, v133, v141
 v_add_f32 v134, v134, v142
 v_cvt_pk_bf16_f32 v136, v128, v128
 v_mfma_f32_32x32x16_bf16 v[48:63], v[200:203], a[88:91], v[48:63]
 ds_read_b128 v[196:199], v5 offset:24576
 v_cvt_pk_bf16_f32 v137, v129, v129
 v_cvt_pk_bf16_f32 v138, v130, v130
 v_cvt_pk_bf16_f32 v139, v131, v131
 v_mfma_f32_32x32x16_bf16 v[64:79], v[204:207], a[88:91], v[64:79]
 ds_read_b128 v[200:203], v5 offset:40960
 v_cvt_pk_bf16_f32 v140, v132, v132
 v_cvt_pk_bf16_f32 v141, v133, v133
 v_cvt_pk_bf16_f32 v142, v134, v134
 s_waitcnt vmcnt(7) lgkmcnt(3)
 v_mfma_f32_32x32x16_bf16 v[16:31], v[208:211], a[92:95], v[16:31]
 ds_read_b128 v[204:207], v5 offset:57344
 buffer_load_dwordx4 a[124:127], v4, s[4:7], s35 offen offset:3072 sc1
 v_and_b32 v136, 0xffff0000, v136
 v_and_b32 v137, 0xffff0000, v137
 v_and_b32 v138, 0xffff0000, v138
 v_mfma_f32_32x32x16_bf16 v[32:47], v[212:215], a[92:95], v[32:47]
 ds_read_b128 v[208:211], v5 offset:9216
 v_and_b32 v139, 0xffff0000, v139
 v_and_b32 v140, 0xffff0000, v140
 v_and_b32 v141, 0xffff0000, v141
 v_mfma_f32_32x32x16_bf16 v[48:63], v[216:219], a[92:95], v[48:63]
 ds_read_b128 v[212:215], v5 offset:25600
 s_add_u32 s46, s44, 131072
 s_add_u32 m0, s45, 131072
 s_nop 0
 buffer_load_dwordx4 v4, s[4:7], s46 offen sc1 lds
 v_and_b32 v142, 0xffff0000, v142
 v_sub_f32 v136, v128, v136
 v_sub_f32 v137, v129, v137
 v_mfma_f32_32x32x16_bf16 v[64:79], v[220:223], a[92:95], v[64:79]
 ds_read_b128 v[216:219], v5 offset:41984
 v_sub_f32 v138, v130, v138
 v_sub_f32 v139, v131, v139
 v_sub_f32 v140, v132, v140
 s_waitcnt vmcnt(8) lgkmcnt(3)
 v_mfma_f32_32x32x16_bf16 v[16:31], v[192:195], a[96:99], v[16:31]
 ds_read_b128 v[220:223], v5 offset:58368
 v_sub_f32 v141, v133, v141
 v_sub_f32 v142, v134, v142
 v_cvt_pk_bf16_f32 v136, v128, v136
 v_mfma_f32_32x32x16_bf16 v[32:47], v[196:199], a[96:99], v[32:47]
 ds_read_b128 v[192:195], v5 offset:10240
 v_cvt_pk_bf16_f32 v137, v129, v137
 v_cvt_pk_bf16_f32 v138, v130, v138
 v_cvt_pk_bf16_f32 v139, v131, v139
 v_mfma_f32_32x32x16_bf16 v[48:63], v[200:203], a[96:99], v[48:63]
 ds_read_b128 v[196:199], v5 offset:26624
 buffer_load_dwordx4 v4, s[4:7], s46 offen offset:1024 sc1 lds
 v_cvt_pk_bf16_f32 v140, v132, v140
 v_cvt_pk_bf16_f32 v141, v133, v141
 v_cvt_pk_bf16_f32 v142, v134, v142
 v_mfma_f32_32x32x16_bf16 v[64:79], v[204:207], a[96:99], v[64:79]
 ds_read_b128 v[200:203], v5 offset:43008
 v_cndmask_b32 v160, 0, v136, vcc
 v_cndmask_b32 v161, 0, v137, vcc
 v_cndmask_b32 v162, 0, v138, vcc
 s_waitcnt vmcnt(8) lgkmcnt(3)
 v_mfma_f32_32x32x16_bf16 v[16:31], v[208:211], a[100:103], v[16:31]
 ds_read_b128 v[204:207], v5 offset:59392
 v_cndmask_b32 v163, 0, v139, vcc
 v_cndmask_b32 v164, 0, v140, vcc
 v_cndmask_b32 v165, 0, v141, vcc
 v_mfma_f32_32x32x16_bf16 v[32:47], v[212:215], a[100:103], v[32:47]
 ds_read_b128 v[208:211], v5 offset:11264
 v_cndmask_b32 v166, 0, v142, vcc
 v_add_f32 v232, v96, v98
 v_add_f32 v232, v232, v100
 v_mfma_f32_32x32x16_bf16 v[48:63], v[216:219], a[100:103], v[48:63]
 ds_read_b128 v[212:215], v5 offset:27648
 buffer_load_dwordx4 v4, s[4:7], s46 offen offset:2048 sc1 lds
 v_add_f32 v232, v232, v102
 v_add_f32 v232, v232, v104
 v_add_f32 v232, v232, v106
 v_mfma_f32_32x32x16_bf16 v[64:79], v[220:223], a[100:103], v[64:79]
 ds_read_b128 v[216:219], v5 offset:44032
 v_add_f32 v232, v232, v108
 v_add_f32 v232, v232, v110
 v_mov_b32 v234, v232
 s_waitcnt vmcnt(8) lgkmcnt(3)
 v_mfma_f32_32x32x16_bf16 v[16:31], v[192:195], a[104:107], v[16:31]
 ds_read_b128 v[220:223], v5 offset:60416
 v_nop
 v_permlane32_swap_b32 v232, v234
 v_add_f32 v232, v232, v234
 v_mfma_f32_32x32x16_bf16 v[32:47], v[196:199], a[104:107], v[32:47]
 ds_read_b128 v[192:195], v5 offset:12288
 v_mul_f32 v232, 0x3d800000, v232
 v_sub_f32 v96, v96, v232
 v_sub_f32 v98, v98, v232
 v_mfma_f32_32x32x16_bf16 v[48:63], v[200:203], a[104:107], v[48:63]
 ds_read_b128 v[196:199], v5 offset:28672
 buffer_load_dwordx4 v4, s[4:7], s46 offen offset:3072 sc1 lds
 v_sub_f32 v100, v100, v232
 v_sub_f32 v102, v102, v232
 v_sub_f32 v104, v104, v232
 v_mfma_f32_32x32x16_bf16 v[64:79], v[204:207], a[104:107], v[64:79]
 ds_read_b128 v[200:203], v5 offset:45056
 v_sub_f32 v106, v106, v232
 v_sub_f32 v108, v108, v232
 v_sub_f32 v110, v110, v232
 s_waitcnt vmcnt(8) lgkmcnt(3)
 v_mfma_f32_32x32x16_bf16 v[16:31], v[208:211], a[108:111], v[16:31]
 ds_read_b128 v[204:207], v5 offset:61440
 v_mul_f32 v233, v96, v96
 v_fmac_f32 v233, v98, v98
 v_fmac_f32 v233, v100, v100
 v_mfma_f32_32x32x16_bf16 v[32:47], v[212:215], a[108:111], v[32:47]
 ds_read_b128 v[208:211], v5 offset:13312
 v_fmac_f32 v233, v102, v102
 v_fmac_f32 v233, v104, v104
 v_fmac_f32 v233, v106, v106
 v_mfma_f32_32x32x16_bf16 v[48:63], v[216:219], a[108:111], v[48:63]
 ds_read_b128 v[212:215], v5 offset:29696
 s_add_u32 s46, s44, 147456
 s_add_u32 m0, s45, 147456
 s_nop 0
 buffer_load_dwordx4 v4, s[4:7], s46 offen sc1 lds
 v_fmac_f32 v233, v108, v108
 v_fmac_f32 v233, v110, v110
 v_mul_f32 v233, 0x42000000, v233
 v_mfma_f32_32x32x16_bf16 v[64:79], v[220:223], a[108:111], v[64:79]
 ds_read_b128 v[216:219], v5 offset:46080
 v_add_f32 v233, v233, v97
 v_add_f32 v233, v233, v99
 v_add_f32 v233, v233, v101
 s_waitcnt vmcnt(8) lgkmcnt(3)
 v_mfma_f32_32x32x16_bf16 v[16:31], v[192:195], a[112:115], v[16:31]
 ds_read_b128 v[220:223], v5 offset:62464
 v_add_f32 v233, v233, v103
 v_add_f32 v233, v233, v105
 v_add_f32 v233, v233, v107
 v_mfma_f32_32x32x16_bf16 v[32:47], v[196:199], a[112:115], v[32:47]
 ds_read_b128 v[192:195], v5 offset:14336
 v_add_f32 v233, v233, v109
 v_add_f32 v233, v233, v111
 v_mov_b32 v234, v233
 v_mfma_f32_32x32x16_bf16 v[48:63], v[200:203], a[112:115], v[48:63]
 ds_read_b128 v[196:199], v5 offset:30720
 buffer_load_dwordx4 v4, s[4:7], s46 offen offset:1024 sc1 lds
 v_nop
 v_permlane32_swap_b32 v233, v234
 v_add_f32 v233, v233, v234
 v_mfma_f32_32x32x16_bf16 v[64:79], v[204:207], a[112:115], v[64:79]
 ds_read_b128 v[200:203], v5 offset:47104
 v_mov_b32 v234, 0x3727c5ac
 v_fmac_f32 v234, 0x3b000000, v233
 v_rsq_f32 v233, v234
 s_waitcnt vmcnt(8) lgkmcnt(3)
 v_mfma_f32_32x32x16_bf16 v[16:31], v[208:211], a[116:119], v[16:31]
 ds_read_b128 v[204:207], v5 offset:63488
 v_mul_f32 v176, 0xbfb8aa3b, v233
 v_sub_f32 v96, 0, v232
 v_cvt_pk_bf16_f32 v97, v96, v96
 v_mfma_f32_32x32x16_bf16 v[32:47], v[212:215], a[116:119], v[32:47]
 ds_read_b128 v[208:211], v5 offset:15360
 v_and_b32 v98, 0xffff0000, v97
 v_sub_f32 v98, v96, v98
 v_cvt_pk_bf16_f32 v98, v98, v98
 v_mfma_f32_32x32x16_bf16 v[48:63], v[216:219], a[116:119], v[48:63]
 ds_read_b128 v[212:215], v5 offset:31744
 buffer_load_dwordx4 v4, s[4:7], s46 offen offset:2048 sc1 lds
 v_cndmask_b32 v168, 0, v97, vcc
 v_cndmask_b32 v169, 0, v98, vcc
 v_mov_b32 v170, 0
 v_mfma_f32_32x32x16_bf16 v[64:79], v[220:223], a[116:119], v[64:79]
 ds_read_b128 v[216:219], v5 offset:48128
 v_mov_b32 v171, 0
 v_mov_b32 v174, 0
 v_mov_b32 v175, 0
 s_waitcnt vmcnt(8) lgkmcnt(3)
 v_mfma_f32_32x32x16_bf16 v[16:31], v[192:195], a[120:123], v[16:31]
 ds_read_b128 v[220:223], v5 offset:64512
 v_mfma_f32_32x32x16_bf16 v[32:47], v[196:199], a[120:123], v[32:47]
 v_mfma_f32_32x32x16_bf16 v[48:63], v[200:203], a[120:123], v[48:63]
 buffer_load_dwordx4 v4, s[4:7], s46 offen offset:3072 sc1 lds
 v_mfma_f32_32x32x16_bf16 v[64:79], v[204:207], a[120:123], v[64:79]
 s_waitcnt vmcnt(8) lgkmcnt(0)
 v_mfma_f32_32x32x16_bf16 v[16:31], v[208:211], a[124:127], v[16:31]
 v_mfma_f32_32x32x16_bf16 v[32:47], v[212:215], a[124:127], v[32:47]
 v_mfma_f32_32x32x16_bf16 v[48:63], v[216:219], a[124:127], v[48:63]
 v_mfma_f32_32x32x16_bf16 v[64:79], v[220:223], a[124:127], v[64:79]
 s_cmp_lg_u32 s29, 0
 s_cbranch_scc1 RS43
 s_lshl_b32 s37, s31, 7
 s_add_u32 s37, s37, 0xf10000
 v_lshlrev_b32 v13, 2, v1
 s_mov_b32 exec_hi, 0
 buffer_store_dword v233, v13, s[4:7], s37 offen sc1
 s_mov_b64 exec, -1
RS43:
 v_mov_b32 v172, v160
 v_mov_b32 v173, v160
 s_nop 1
 v_mfma_f32_32x32x16_bf16 v[16:31], v[172:175], v[168:171], v[16:31]
 v_mov_b32 v172, v161
 v_mov_b32 v173, v161
 s_nop 1
 v_mfma_f32_32x32x16_bf16 v[32:47], v[172:175], v[168:171], v[32:47]
 v_mov_b32 v172, v162
 v_mov_b32 v173, v162
 s_nop 1
 v_mfma_f32_32x32x16_bf16 v[48:63], v[172:175], v[168:171], v[48:63]
 v_mov_b32 v172, v163
 v_mov_b32 v173, v163
 s_nop 1
 v_mfma_f32_32x32x16_bf16 v[64:79], v[172:175], v[168:171], v[64:79]
 s_mul_i32 s47, s20, 458752
 s_lshl_b32 s48, s27, 11
 s_add_u32 s47, s47, s48
 s_add_u32 s47, s47, 0x1400000
 v_mov_b32 v172, v164
 v_mov_b32 v173, v164
 s_nop 1
 v_mfma_f32_32x32x16_bf16 v[80:95], v[172:175], v[168:171], 0
 s_waitcnt vmcnt(4)
 s_barrier
 ds_read_b128 v[192:195], v6 offset:0
 ds_read_b128 v[196:199], v6 offset:1024
 ds_read_b128 v[200:203], v6 offset:2048
 ds_read_b128 v[204:207], v6 offset:3072
 ds_read_b128 v[208:211], v6 offset:4096
 ds_read_b128 v[212:215], v6 offset:5120
 ds_read_b128 v[216:219], v6 offset:6144
 s_waitcnt lgkmcnt(3)
 v_mfma_f32_32x32x16_bf16 v[80:95], v[192:195], a[0:3], v[80:95]
 ds_read_b128 v[220:223], v6 offset:7168
 s_add_u32 s46, s44, 163840
 s_add_u32 m0, s45, 0
 s_nop 0
 buffer_load_dwordx4 v4, s[4:7], s46 offen sc1 lds
 v_mul_f32 v224, v176, v16
 v_mul_f32 v225, v176, v17
 v_mul_f32 v226, v176, v18
 v_mfma_f32_32x32x16_bf16 v[80:95], v[196:199], a[4:7], v[80:95]
 ds_read_b128 v[192:195], v6 offset:8192
 buffer_load_dwordx4 v4, s[4:7], s46 offen offset:1024 sc1 lds
 v_mul_f32 v227, v176, v19
 v_exp_f32 v224, v224
 v_exp_f32 v225, v225
 v_mfma_f32_32x32x16_bf16 v[80:95], v[200:203], a[8:11], v[80:95]
 ds_read_b128 v[196:199], v6 offset:9216
 buffer_load_dwordx4 v4, s[4:7], s46 offen offset:2048 sc1 lds
 v_exp_f32 v226, v226
 v_exp_f32 v227, v227
 v_add_f32 v224, 1.0, v224
 v_mfma_f32_32x32x16_bf16 v[80:95], v[204:207], a[12:15], v[80:95]
 ds_read_b128 v[200:203], v6 offset:10240
 buffer_load_dwordx4 v4, s[4:7], s46 offen offset:3072 sc1 lds
 v_add_f32 v225, 1.0, v225
 v_add_f32 v226, 1.0, v226
 v_add_f32 v227, 1.0, v227
 s_waitcnt lgkmcnt(3)
 v_mfma_f32_32x32x16_bf16 v[80:95], v[208:211], a[16:19], v[80:95]
 ds_read_b128 v[204:207], v6 offset:11264
 s_add_u32 s46, s44, 180224
 s_add_u32 m0, s45, 16384
 s_nop 0
 buffer_load_dwordx4 v4, s[4:7], s46 offen sc1 lds
 v_rcp_f32 v224, v224
 v_rcp_f32 v225, v225
 v_rcp_f32 v226, v226
 v_mfma_f32_32x32x16_bf16 v[80:95], v[212:215], a[20:23], v[80:95]
 ds_read_b128 v[208:211], v6 offset:12288
 buffer_load_dwordx4 v4, s[4:7], s46 offen offset:1024 sc1 lds
 v_rcp_f32 v227, v227
 v_mul_f32 v224, v24, v224
 v_mul_f32 v225, v25, v225
 v_mfma_f32_32x32x16_bf16 v[80:95], v[216:219], a[24:27], v[80:95]
 ds_read_b128 v[212:215], v6 offset:13312
 buffer_load_dwordx4 v4, s[4:7], s46 offen offset:2048 sc1 lds
 v_mul_f32 v226, v26, v226
 v_mul_f32 v227, v27, v227
 v_cvt_pk_bf16_f32 v232, v224, v225
 v_mfma_f32_32x32x16_bf16 v[80:95], v[220:223], a[28:31], v[80:95]
 ds_read_b128 v[216:219], v6 offset:14336
 buffer_load_dwordx4 v4, s[4:7], s46 offen offset:3072 sc1 lds
 v_cvt_pk_bf16_f32 v233, v226, v227
 v_mul_f32 v224, v176, v20
 v_mul_f32 v225, v176, v21
 s_waitcnt lgkmcnt(3)
 v_mfma_f32_32x32x16_bf16 v[80:95], v[192:195], a[32:35], v[80:95]
 ds_read_b128 v[220:223], v6 offset:15360
 s_add_u32 s46, s44, 196608
 s_add_u32 m0, s45, 32768
 s_nop 0
 buffer_load_dwordx4 v4, s[4:7], s46 offen sc1 lds
 v_mul_f32 v226, v176, v22
 v_mul_f32 v227, v176, v23
 v_exp_f32 v224, v224
 v_mfma_f32_32x32x16_bf16 v[80:95], v[196:199], a[36:39], v[80:95]
 s_waitcnt vmcnt(9)
 s_barrier
 ds_read_b128 v[192:195], v6 offset:16384
 buffer_load_dwordx4 v4, s[4:7], s46 offen offset:1024 sc1 lds
 v_exp_f32 v225, v225
 v_exp_f32 v226, v226
 v_exp_f32 v227, v227
 v_mfma_f32_32x32x16_bf16 v[80:95], v[200:203], a[40:43], v[80:95]
 ds_read_b128 v[196:199], v6 offset:17408
 buffer_load_dwordx4 v4, s[4:7], s46 offen offset:2048 sc1 lds
 v_add_f32 v224, 1.0, v224
 v_add_f32 v225, 1.0, v225
 v_add_f32 v226, 1.0, v226
 v_mfma_f32_32x32x16_bf16 v[80:95], v[204:207], a[44:47], v[80:95]
 ds_read_b128 v[200:203], v6 offset:18432
 buffer_load_dwordx4 v4, s[4:7], s46 offen offset:3072 sc1 lds
 v_add_f32 v227, 1.0, v227
 v_rcp_f32 v224, v224
 v_rcp_f32 v225, v225
 s_waitcnt lgkmcnt(3)
 v_mfma_f32_32x32x16_bf16 v[80:95], v[208:211], a[48:51], v[80:95]
 ds_read_b128 v[204:207], v6 offset:19456
 s_add_u32 s46, s44, 212992
 s_add_u32 m0, s45, 49152
 s_nop 0
 buffer_load_dwordx4 v4, s[4:7], s46 offen sc1 lds
 v_rcp_f32 v226, v226
 v_rcp_f32 v227, v227
 v_mul_f32 v224, v28, v224
 v_mfma_f32_32x32x16_bf16 v[80:95], v[212:215], a[52:55], v[80:95]
 ds_read_b128 v[208:211], v6 offset:20480
 buffer_load_dwordx4 v4, s[4:7], s46 offen offset:1024 sc1 lds
 v_mul_f32 v225, v29, v225
 v_mul_f32 v226, v30, v226
 v_mul_f32 v227, v31, v227
 v_mfma_f32_32x32x16_bf16 v[80:95], v[216:219], a[56:59], v[80:95]
 ds_read_b128 v[212:215], v6 offset:21504
 buffer_load_dwordx4 v4, s[4:7], s46 offen offset:2048 sc1 lds
 v_cvt_pk_bf16_f32 v234, v224, v225
 v_cvt_pk_bf16_f32 v235, v226, v227
 s_add_u32 s41, s36, 0
 buffer_store_dwordx4 v[232:235], v4, s[4:7], s41 offen sc1
 v_mfma_f32_32x32x16_bf16 v[80:95], v[220:223], a[60:63], v[80:95]
 ds_read_b128 v[216:219], v6 offset:22528
 buffer_load_dwordx4 v4, s[4:7], s46 offen offset:3072 sc1 lds
 v_mul_f32 v224, v176, v32
 v_mul_f32 v225, v176, v33
 v_mul_f32 v226, v176, v34
 s_waitcnt lgkmcnt(3)
 v_mfma_f32_32x32x16_bf16 v[80:95], v[192:195], a[64:67], v[80:95]
 ds_read_b128 v[220:223], v6 offset:23552
 s_add_u32 s49, s47, 0
 buffer_load_dwordx4 a[128:131], v4, s[4:7], s49 offen sc1
 v_mul_f32 v227, v176, v35
 v_exp_f32 v224, v224
 v_exp_f32 v225, v225
 v_mfma_f32_32x32x16_bf16 v[80:95], v[196:199], a[68:71], v[80:95]
 ds_read_b128 v[192:195], v6 offset:24576
 v_exp_f32 v226, v226
 v_exp_f32 v227, v227
 v_add_f32 v224, 1.0, v224
 v_mfma_f32_32x32x16_bf16 v[80:95], v[200:203], a[72:75], v[80:95]
 ds_read_b128 v[196:199], v6 offset:25600
 buffer_load_dwordx4 a[132:135], v4, s[4:7], s49 offen offset:1024 sc1
 v_add_f32 v225, 1.0, v225
 v_add_f32 v226, 1.0, v226
 v_add_f32 v227, 1.0, v227
 v_mfma_f32_32x32x16_bf16 v[80:95], v[204:207], a[76:79], v[80:95]
 ds_read_b128 v[200:203], v6 offset:26624
 v_rcp_f32 v224, v224
 v_rcp_f32 v225, v225
 v_rcp_f32 v226, v226
 s_waitcnt lgkmcnt(3)
 v_mfma_f32_32x32x16_bf16 v[80:95], v[208:211], a[80:83], v[80:95]
 ds_read_b128 v[204:207], v6 offset:27648
 s_add_u32 s49, s47, 16384
 buffer_load_dwordx4 a[136:139], v4, s[4:7], s49 offen sc1
 v_rcp_f32 v227, v227
 v_mul_f32 v224, v40, v224
 v_mul_f32 v225, v41, v225
 v_mfma_f32_32x32x16_bf16 v[80:95], v[212:215], a[84:87], v[80:95]
 ds_read_b128 v[208:211], v6 offset:28672
 v_mul_f32 v226, v42, v226
 v_mul_f32 v227, v43, v227
 v_cvt_pk_bf16_f32 v236, v224, v225
 v_mfma_f32_32x32x16_bf16 v[80:95], v[216:219], a[88:91], v[80:95]
 ds_read_b128 v[212:215], v6 offset:29696
 buffer_load_dwordx4 a[140:143], v4, s[4:7], s49 offen offset:1024 sc1
 v_cvt_pk_bf16_f32 v237, v226, v227
 v_mul_f32 v224, v176, v36
 v_mul_f32 v225, v176, v37
 v_mfma_f32_32x32x16_bf16 v[80:95], v[220:223], a[92:95], v[80:95]
 ds_read_b128 v[216:219], v6 offset:30720
 v_mul_f32 v226, v176, v38
 v_mul_f32 v227, v176, v39
 v_exp_f32 v224, v224
 s_waitcnt lgkmcnt(3)
 v_mfma_f32_32x32x16_bf16 v[80:95], v[192:195], a[96:99], v[80:95]
 ds_read_b128 v[220:223], v6 offset:31744
 s_add_u32 s49, s47, 32768
 buffer_load_dwordx4 a[144:147], v4, s[4:7], s49 offen sc1
 v_exp_f32 v225, v225
 v_exp_f32 v226, v226
 v_exp_f32 v227, v227
 v_mfma_f32_32x32x16_bf16 v[80:95], v[196:199], a[100:103], v[80:95]
 v_add_f32 v224, 1.0, v224
 v_add_f32 v225, 1.0, v225
 v_add_f32 v226, 1.0, v226
 v_mfma_f32_32x32x16_bf16 v[80:95], v[200:203], a[104:107], v[80:95]
 buffer_load_dwordx4 a[148:151], v4, s[4:7], s49 offen offset:1024 sc1
 v_add_f32 v227, 1.0, v227
 v_rcp_f32 v224, v224
 v_rcp_f32 v225, v225
 v_mfma_f32_32x32x16_bf16 v[80:95], v[204:207], a[108:111], v[80:95]
 v_rcp_f32 v226, v226
 v_rcp_f32 v227, v227
 v_mul_f32 v224, v44, v224
 s_waitcnt lgkmcnt(0)
 v_mfma_f32_32x32x16_bf16 v[80:95], v[208:211], a[112:115], v[80:95]
 s_add_u32 s49, s47, 49152
 buffer_load_dwordx4 a[152:155], v4, s[4:7], s49 offen sc1
 v_mul_f32 v225, v45, v225
 v_mul_f32 v226, v46, v226
 v_mul_f32 v227, v47, v227
 v_mfma_f32_32x32x16_bf16 v[80:95], v[212:215], a[116:119], v[80:95]
 v_cvt_pk_bf16_f32 v238, v224, v225
 v_cvt_pk_bf16_f32 v239, v226, v227
 s_add_u32 s41, s36, 1024
 buffer_store_dwordx4 v[236:239], v4, s[4:7], s41 offen sc1
 v_mfma_f32_32x32x16_bf16 v[80:95], v[216:219], a[120:123], v[80:95]
 buffer_load_dwordx4 a[156:159], v4, s[4:7], s49 offen offset:1024 sc1
 v_mfma_f32_32x32x16_bf16 v[80:95], v[220:223], a[124:127], v[80:95]
 v_mov_b32 v172, v165
 v_mov_b32 v173, v165
 s_nop 1
 v_mfma_f32_32x32x16_bf16 v[112:127], v[172:175], v[168:171], 0
 s_waitcnt vmcnt(22)
 s_barrier
 ds_read_b128 v[192:195], v4 offset:0
 ds_read_b128 v[196:199], v4 offset:1024
 ds_read_b128 v[200:203], v4 offset:2048
 ds_read_b128 v[204:207], v4 offset:3072
 ds_read_b128 v[208:211], v4 offset:4096
 ds_read_b128 v[212:215], v4 offset:5120
 ds_read_b128 v[216:219], v4 offset:6144
 s_waitcnt lgkmcnt(3)
 v_mfma_f32_32x32x16_bf16 v[112:127], v[192:195], a[0:3], v[112:127]
 ds_read_b128 v[220:223], v4 offset:7168
 s_add_u32 s49, s47, 65536
 buffer_load_dwordx4 a[160:163], v4, s[4:7], s49 offen sc1
 v_mul_f32 v224, v176, v48
 v_mul_f32 v225, v176, v49
 v_mul_f32 v226, v176, v50
 v_mfma_f32_32x32x16_bf16 v[112:127], v[196:199], a[4:7], v[112:127]
 ds_read_b128 v[192:195], v4 offset:8192
 v_mul_f32 v227, v176, v51
 v_exp_f32 v224, v224
 v_exp_f32 v225, v225
 v_mfma_f32_32x32x16_bf16 v[112:127], v[200:203], a[8:11], v[112:127]
 ds_read_b128 v[196:199], v4 offset:9216
 buffer_load_dwordx4 a[164:167], v4, s[4:7], s49 offen offset:1024 sc1
 v_exp_f32 v226, v226
 v_exp_f32 v227, v227
 v_add_f32 v224, 1.0, v224
 v_mfma_f32_32x32x16_bf16 v[112:127], v[204:207], a[12:15], v[112:127]
 ds_read_b128 v[200:203], v4 offset:10240
 v_add_f32 v225, 1.0, v225
 v_add_f32 v226, 1.0, v226
 v_add_f32 v227, 1.0, v227
 s_waitcnt lgkmcnt(3)
 v_mfma_f32_32x32x16_bf16 v[112:127], v[208:211], a[16:19], v[112:127]
 ds_read_b128 v[204:207], v4 offset:11264
 s_add_u32 s49, s47, 81920
 buffer_load_dwordx4 a[168:171], v4, s[4:7], s49 offen sc1
 v_rcp_f32 v224, v224
 v_rcp_f32 v225, v225
 v_rcp_f32 v226, v226
 v_mfma_f32_32x32x16_bf16 v[112:127], v[212:215], a[20:23], v[112:127]
 ds_read_b128 v[208:211], v4 offset:12288
 v_rcp_f32 v227, v227
 v_mul_f32 v224, v56, v224
 v_mul_f32 v225, v57, v225
 v_mfma_f32_32x32x16_bf16 v[112:127], v[216:219], a[24:27], v[112:127]
 ds_read_b128 v[212:215], v4 offset:13312
 buffer_load_dwordx4 a[172:175], v4, s[4:7], s49 offen offset:1024 sc1
 v_mul_f32 v226, v58, v226
 v_mul_f32 v227, v59, v227
 v_cvt_pk_bf16_f32 v232, v224, v225
 v_mfma_f32_32x32x16_bf16 v[112:127], v[220:223], a[28:31], v[112:127]
 ds_read_b128 v[216:219], v4 offset:14336
 v_cvt_pk_bf16_f32 v233, v226, v227
 v_mul_f32 v224, v176, v52
 v_mul_f32 v225, v176, v53
 s_waitcnt lgkmcnt(3)
 v_mfma_f32_32x32x16_bf16 v[112:127], v[192:195], a[32:35], v[112:127]
 ds_read_b128 v[220:223], v4 offset:15360
 s_add_u32 s49, s47, 98304
 buffer_load_dwordx4 a[176:179], v4, s[4:7], s49 offen sc1
 v_mul_f32 v226, v176, v54
 v_mul_f32 v227, v176, v55
 v_exp_f32 v224, v224
 v_mfma_f32_32x32x16_bf16 v[112:127], v[196:199], a[36:39], v[112:127]
 s_waitcnt vmcnt(23)
 s_barrier
 ds_read_b128 v[192:195], v4 offset:16384
 v_exp_f32 v225, v225
 v_exp_f32 v226, v226
 v_exp_f32 v227, v227
 v_mfma_f32_32x32x16_bf16 v[112:127], v[200:203], a[40:43], v[112:127]
 ds_read_b128 v[196:199], v4 offset:17408
 buffer_load_dwordx4 a[180:183], v4, s[4:7], s49 offen offset:1024 sc1
 v_add_f32 v224, 1.0, v224
 v_add_f32 v225, 1.0, v225
 v_add_f32 v226, 1.0, v226
 v_mfma_f32_32x32x16_bf16 v[112:127], v[204:207], a[44:47], v[112:127]
 ds_read_b128 v[200:203], v4 offset:18432
 v_add_f32 v227, 1.0, v227
 v_rcp_f32 v224, v224
 v_rcp_f32 v225, v225
 s_waitcnt lgkmcnt(3)
 v_mfma_f32_32x32x16_bf16 v[112:127], v[208:211], a[48:51], v[112:127]
 ds_read_b128 v[204:207], v4 offset:19456
 s_add_u32 s49, s47, 114688
 buffer_load_dwordx4 a[184:187], v4, s[4:7], s49 offen sc1
 v_rcp_f32 v226, v226
 v_rcp_f32 v227, v227
 v_mul_f32 v224, v60, v224
 v_mfma_f32_32x32x16_bf16 v[112:127], v[212:215], a[52:55], v[112:127]
 ds_read_b128 v[208:211], v4 offset:20480
 v_mul_f32 v225, v61, v225
 v_mul_f32 v226, v62, v226
 v_mul_f32 v227, v63, v227
 v_mfma_f32_32x32x16_bf16 v[112:127], v[216:219], a[56:59], v[112:127]
 ds_read_b128 v[212:215], v4 offset:21504
 buffer_load_dwordx4 a[188:191], v4, s[4:7], s49 offen offset:1024 sc1
 v_cvt_pk_bf16_f32 v234, v224, v225
 v_cvt_pk_bf16_f32 v235, v226, v227
 s_add_u32 s41, s36, 2048
 buffer_store_dwordx4 v[232:235], v4, s[4:7], s41 offen sc1
 v_mfma_f32_32x32x16_bf16 v[112:127], v[220:223], a[60:63], v[112:127]
 ds_read_b128 v[216:219], v4 offset:22528
 v_mul_f32 v224, v176, v64
 v_mul_f32 v225, v176, v65
 v_mul_f32 v226, v176, v66
 s_waitcnt lgkmcnt(3)
 v_mfma_f32_32x32x16_bf16 v[112:127], v[192:195], a[64:67], v[112:127]
 ds_read_b128 v[220:223], v4 offset:23552
 s_add_u32 s49, s47, 131072
 buffer_load_dwordx4 a[192:195], v4, s[4:7], s49 offen sc1
 v_mul_f32 v227, v176, v67
 v_exp_f32 v224, v224
 v_exp_f32 v225, v225
 v_mfma_f32_32x32x16_bf16 v[112:127], v[196:199], a[68:71], v[112:127]
 ds_read_b128 v[192:195], v4 offset:24576
 v_exp_f32 v226, v226
 v_exp_f32 v227, v227
 v_add_f32 v224, 1.0, v224
 v_mfma_f32_32x32x16_bf16 v[112:127], v[200:203], a[72:75], v[112:127]
 ds_read_b128 v[196:199], v4 offset:25600
 buffer_load_dwordx4 a[196:199], v4, s[4:7], s49 offen offset:1024 sc1
 v_add_f32 v225, 1.0, v225
 v_add_f32 v226, 1.0, v226
 v_add_f32 v227, 1.0, v227
 v_mfma_f32_32x32x16_bf16 v[112:127], v[204:207], a[76:79], v[112:127]
 ds_read_b128 v[200:203], v4 offset:26624
 v_rcp_f32 v224, v224
 v_rcp_f32 v225, v225
 v_rcp_f32 v226, v226
 s_waitcnt lgkmcnt(3)
 v_mfma_f32_32x32x16_bf16 v[112:127], v[208:211], a[80:83], v[112:127]
 ds_read_b128 v[204:207], v4 offset:27648
 s_add_u32 s49, s47, 147456
 buffer_load_dwordx4 a[200:203], v4, s[4:7], s49 offen sc1
 v_rcp_f32 v227, v227
 v_mul_f32 v224, v72, v224
 v_mul_f32 v225, v73, v225
 v_mfma_f32_32x32x16_bf16 v[112:127], v[212:215], a[84:87], v[112:127]
 ds_read_b128 v[208:211], v4 offset:28672
 v_mul_f32 v226, v74, v226
 v_mul_f32 v227, v75, v227
 v_cvt_pk_bf16_f32 v236, v224, v225
 v_mfma_f32_32x32x16_bf16 v[112:127], v[216:219], a[88:91], v[112:127]
 ds_read_b128 v[212:215], v4 offset:29696
 buffer_load_dwordx4 a[204:207], v4, s[4:7], s49 offen offset:1024 sc1
 v_cvt_pk_bf16_f32 v237, v226, v227
 v_mul_f32 v224, v176, v68
 v_mul_f32 v225, v176, v69
 v_mfma_f32_32x32x16_bf16 v[112:127], v[220:223], a[92:95], v[112:127]
 ds_read_b128 v[216:219], v4 offset:30720
 v_mul_f32 v226, v176, v70
 v_mul_f32 v227, v176, v71
 v_exp_f32 v224, v224
 s_waitcnt lgkmcnt(3)
 v_mfma_f32_32x32x16_bf16 v[112:127], v[192:195], a[96:99], v[112:127]
 ds_read_b128 v[220:223], v4 offset:31744
 s_add_u32 s49, s47, 163840
 buffer_load_dwordx4 a[208:211], v4, s[4:7], s49 offen sc1
 v_exp_f32 v225, v225
 v_exp_f32 v226, v226
 v_exp_f32 v227, v227
 v_mfma_f32_32x32x16_bf16 v[112:127], v[196:199], a[100:103], v[112:127]
 v_add_f32 v224, 1.0, v224
 v_add_f32 v225, 1.0, v225
 v_add_f32 v226, 1.0, v226
 v_mfma_f32_32x32x16_bf16 v[112:127], v[200:203], a[104:107], v[112:127]
 buffer_load_dwordx4 a[212:215], v4, s[4:7], s49 offen offset:1024 sc1
 v_add_f32 v227, 1.0, v227
 v_rcp_f32 v224, v224
 v_rcp_f32 v225, v225
 v_mfma_f32_32x32x16_bf16 v[112:127], v[204:207], a[108:111], v[112:127]
 v_rcp_f32 v226, v226
 v_rcp_f32 v227, v227
 v_mul_f32 v224, v76, v224
 s_waitcnt lgkmcnt(0)
 v_mfma_f32_32x32x16_bf16 v[112:127], v[208:211], a[112:115], v[112:127]
 s_add_u32 s49, s47, 180224
 buffer_load_dwordx4 a[216:219], v4, s[4:7], s49 offen sc1
 v_mul_f32 v225, v77, v225
 v_mul_f32 v226, v78, v226
 v_mul_f32 v227, v79, v227
 v_mfma_f32_32x32x16_bf16 v[112:127], v[212:215], a[116:119], v[112:127]
 v_cvt_pk_bf16_f32 v238, v224, v225
 v_cvt_pk_bf16_f32 v239, v226, v227
 s_add_u32 s41, s36, 3072
 buffer_store_dwordx4 v[236:239], v4, s[4:7], s41 offen sc1
 v_mfma_f32_32x32x16_bf16 v[112:127], v[216:219], a[120:123], v[112:127]
 buffer_load_dwordx4 a[220:223], v4, s[4:7], s49 offen offset:1024 sc1
 v_mfma_f32_32x32x16_bf16 v[112:127], v[220:223], a[124:127], v[112:127]
 v_mov_b32 v172, v166
 v_mov_b32 v173, v166
 s_nop 1
 v_mfma_f32_32x32x16_bf16 v[16:31], v[172:175], v[168:171], 0
 s_waitcnt vmcnt(32)
 s_barrier
 ds_read_b128 v[192:195], v4 offset:32768
 ds_read_b128 v[196:199], v4 offset:33792
 ds_read_b128 v[200:203], v4 offset:34816
 ds_read_b128 v[204:207], v4 offset:35840
 ds_read_b128 v[208:211], v4 offset:36864
 ds_read_b128 v[212:215], v4 offset:37888
 ds_read_b128 v[216:219], v4 offset:38912
 s_waitcnt lgkmcnt(3)
 v_mfma_f32_32x32x16_bf16 v[16:31], v[192:195], a[0:3], v[16:31]
 ds_read_b128 v[220:223], v4 offset:39936
 s_add_u32 s49, s47, 196608
 buffer_load_dwordx4 a[224:227], v4, s[4:7], s49 offen sc1
 v_mul_f32 v224, v176, v80
 v_mul_f32 v225, v176, v81
 v_mul_f32 v226, v176, v82
 v_mfma_f32_32x32x16_bf16 v[16:31], v[196:199], a[4:7], v[16:31]
 ds_read_b128 v[192:195], v4 offset:40960
 v_mul_f32 v227, v176, v83
 v_exp_f32 v224, v224
 v_exp_f32 v225, v225
 v_mfma_f32_32x32x16_bf16 v[16:31], v[200:203], a[8:11], v[16:31]
 ds_read_b128 v[196:199], v4 offset:41984
 buffer_load_dwordx4 a[228:231], v4, s[4:7], s49 offen offset:1024 sc1
 v_exp_f32 v226, v226
 v_exp_f32 v227, v227
 v_add_f32 v224, 1.0, v224
 v_mfma_f32_32x32x16_bf16 v[16:31], v[204:207], a[12:15], v[16:31]
 ds_read_b128 v[200:203], v4 offset:43008
 v_add_f32 v225, 1.0, v225
 v_add_f32 v226, 1.0, v226
 v_add_f32 v227, 1.0, v227
 s_waitcnt lgkmcnt(3)
 v_mfma_f32_32x32x16_bf16 v[16:31], v[208:211], a[16:19], v[16:31]
 ds_read_b128 v[204:207], v4 offset:44032
 s_add_u32 s49, s47, 212992
 buffer_load_dwordx4 a[232:235], v4, s[4:7], s49 offen sc1
 v_rcp_f32 v224, v224
 v_rcp_f32 v225, v225
 v_rcp_f32 v226, v226
 v_mfma_f32_32x32x16_bf16 v[16:31], v[212:215], a[20:23], v[16:31]
 ds_read_b128 v[208:211], v4 offset:45056
 v_rcp_f32 v227, v227
 v_mul_f32 v224, v88, v224
 v_mul_f32 v225, v89, v225
 v_mfma_f32_32x32x16_bf16 v[16:31], v[216:219], a[24:27], v[16:31]
 ds_read_b128 v[212:215], v4 offset:46080
 buffer_load_dwordx4 a[236:239], v4, s[4:7], s49 offen offset:1024 sc1
 v_mul_f32 v226, v90, v226
 v_mul_f32 v227, v91, v227
 v_cvt_pk_bf16_f32 v232, v224, v225
 v_mfma_f32_32x32x16_bf16 v[16:31], v[220:223], a[28:31], v[16:31]
 ds_read_b128 v[216:219], v4 offset:47104
 v_cvt_pk_bf16_f32 v233, v226, v227
 v_mul_f32 v224, v176, v84
 v_mul_f32 v225, v176, v85
 s_waitcnt lgkmcnt(3)
 v_mfma_f32_32x32x16_bf16 v[16:31], v[192:195], a[32:35], v[16:31]
 ds_read_b128 v[220:223], v4 offset:48128
 s_add_u32 s49, s47, 229376
 buffer_load_dwordx4 a[240:243], v4, s[4:7], s49 offen sc1
 v_mul_f32 v226, v176, v86
 v_mul_f32 v227, v176, v87
 v_exp_f32 v224, v224
 v_mfma_f32_32x32x16_bf16 v[16:31], v[196:199], a[36:39], v[16:31]
 s_waitcnt vmcnt(32)
 s_barrier
 ds_read_b128 v[192:195], v4 offset:49152
 v_exp_f32 v225, v225
 v_exp_f32 v226, v226
 v_exp_f32 v227, v227
 v_mfma_f32_32x32x16_bf16 v[16:31], v[200:203], a[40:43], v[16:31]
 ds_read_b128 v[196:199], v4 offset:50176
 buffer_load_dwordx4 a[244:247], v4, s[4:7], s49 offen offset:1024 sc1
 v_add_f32 v224, 1.0, v224
 v_add_f32 v225, 1.0, v225
 v_add_f32 v226, 1.0, v226
 v_mfma_f32_32x32x16_bf16 v[16:31], v[204:207], a[44:47], v[16:31]
 ds_read_b128 v[200:203], v4 offset:51200
 v_add_f32 v227, 1.0, v227
 v_rcp_f32 v224, v224
 v_rcp_f32 v225, v225
 s_waitcnt lgkmcnt(3)
 v_mfma_f32_32x32x16_bf16 v[16:31], v[208:211], a[48:51], v[16:31]
 ds_read_b128 v[204:207], v4 offset:52224
 s_add_u32 s49, s47, 245760
 buffer_load_dwordx4 a[248:251], v4, s[4:7], s49 offen sc1
 v_rcp_f32 v226, v226
 v_rcp_f32 v227, v227
 v_mul_f32 v224, v92, v224
 v_mfma_f32_32x32x16_bf16 v[16:31], v[212:215], a[52:55], v[16:31]
 ds_read_b128 v[208:211], v4 offset:53248
 v_mul_f32 v225, v93, v225
 v_mul_f32 v226, v94, v226
 v_mul_f32 v227, v95, v227
 v_mfma_f32_32x32x16_bf16 v[16:31], v[216:219], a[56:59], v[16:31]
 ds_read_b128 v[212:215], v4 offset:54272
 buffer_load_dwordx4 a[252:255], v4, s[4:7], s49 offen offset:1024 sc1
 v_cvt_pk_bf16_f32 v234, v224, v225
 v_cvt_pk_bf16_f32 v235, v226, v227
 s_add_u32 s41, s36, 4096
 buffer_store_dwordx4 v[232:235], v4, s[4:7], s41 offen sc1
 v_mfma_f32_32x32x16_bf16 v[16:31], v[220:223], a[60:63], v[16:31]
 ds_read_b128 v[216:219], v4 offset:55296
 v_mul_f32 v224, v176, v112
 v_mul_f32 v225, v176, v113
 v_mul_f32 v226, v176, v114
 s_waitcnt lgkmcnt(3)
 v_mfma_f32_32x32x16_bf16 v[16:31], v[192:195], a[64:67], v[16:31]
 ds_read_b128 v[220:223], v4 offset:56320
 v_mul_f32 v227, v176, v115
 v_exp_f32 v224, v224
 v_exp_f32 v225, v225
 v_mfma_f32_32x32x16_bf16 v[16:31], v[196:199], a[68:71], v[16:31]
 ds_read_b128 v[192:195], v4 offset:57344
 v_exp_f32 v226, v226
 v_exp_f32 v227, v227
 v_add_f32 v224, 1.0, v224
 v_mfma_f32_32x32x16_bf16 v[16:31], v[200:203], a[72:75], v[16:31]
 ds_read_b128 v[196:199], v4 offset:58368
 v_add_f32 v225, 1.0, v225
 v_add_f32 v226, 1.0, v226
 v_add_f32 v227, 1.0, v227
 v_mfma_f32_32x32x16_bf16 v[16:31], v[204:207], a[76:79], v[16:31]
 ds_read_b128 v[200:203], v4 offset:59392
 v_rcp_f32 v224, v224
 v_rcp_f32 v225, v225
 v_rcp_f32 v226, v226
 s_waitcnt lgkmcnt(3)
 v_mfma_f32_32x32x16_bf16 v[16:31], v[208:211], a[80:83], v[16:31]
 ds_read_b128 v[204:207], v4 offset:60416
 v_rcp_f32 v227, v227
 v_mul_f32 v224, v120, v224
 v_mul_f32 v225, v121, v225
 v_mfma_f32_32x32x16_bf16 v[16:31], v[212:215], a[84:87], v[16:31]
 ds_read_b128 v[208:211], v4 offset:61440
 v_mul_f32 v226, v122, v226
 v_mul_f32 v227, v123, v227
 v_cvt_pk_bf16_f32 v236, v224, v225
 v_mfma_f32_32x32x16_bf16 v[16:31], v[216:219], a[88:91], v[16:31]
 ds_read_b128 v[212:215], v4 offset:62464
 v_cvt_pk_bf16_f32 v237, v226, v227
 v_mul_f32 v224, v176, v116
 v_mul_f32 v225, v176, v117
 v_mfma_f32_32x32x16_bf16 v[16:31], v[220:223], a[92:95], v[16:31]
 ds_read_b128 v[216:219], v4 offset:63488
 v_mul_f32 v226, v176, v118
 v_mul_f32 v227, v176, v119
 v_exp_f32 v224, v224
 s_waitcnt lgkmcnt(3)
 v_mfma_f32_32x32x16_bf16 v[16:31], v[192:195], a[96:99], v[16:31]
 ds_read_b128 v[220:223], v4 offset:64512
 v_exp_f32 v225, v225
 v_exp_f32 v226, v226
 v_exp_f32 v227, v227
 v_mfma_f32_32x32x16_bf16 v[16:31], v[196:199], a[100:103], v[16:31]
 v_add_f32 v224, 1.0, v224
 v_add_f32 v225, 1.0, v225
 v_add_f32 v226, 1.0, v226
 v_mfma_f32_32x32x16_bf16 v[16:31], v[200:203], a[104:107], v[16:31]
 v_add_f32 v227, 1.0, v227
 v_rcp_f32 v224, v224
 v_rcp_f32 v225, v225
 v_mfma_f32_32x32x16_bf16 v[16:31], v[204:207], a[108:111], v[16:31]
 v_rcp_f32 v226, v226
 v_rcp_f32 v227, v227
 v_mul_f32 v224, v124, v224
 s_waitcnt lgkmcnt(0)
 v_mfma_f32_32x32x16_bf16 v[16:31], v[208:211], a[112:115], v[16:31]
 v_mul_f32 v225, v125, v225
 v_mul_f32 v226, v126, v226
 v_mul_f32 v227, v127, v227
 v_mfma_f32_32x32x16_bf16 v[16:31], v[212:215], a[116:119], v[16:31]
 v_cvt_pk_bf16_f32 v238, v224, v225
 v_cvt_pk_bf16_f32 v239, v226, v227
 s_add_u32 s41, s36, 5120
 buffer_store_dwordx4 v[236:239], v4, s[4:7], s41 offen sc1
 v_mfma_f32_32x32x16_bf16 v[16:31], v[216:219], a[120:123], v[16:31]
 v_mfma_f32_32x32x16_bf16 v[16:31], v[220:223], a[124:127], v[16:31]
 s_barrier
 s_nop 10
 v_mul_f32 v224, v176, v16
 v_mul_f32 v225, v176, v17
 v_mul_f32 v226, v176, v18
 v_mul_f32 v227, v176, v19
 v_exp_f32 v224, v224
 v_exp_f32 v225, v225
 v_exp_f32 v226, v226
 v_exp_f32 v227, v227
 v_add_f32 v224, 1.0, v224
 v_add_f32 v225, 1.0, v225
 v_add_f32 v226, 1.0, v226
 v_add_f32 v227, 1.0, v227
 v_rcp_f32 v224, v224
 v_rcp_f32 v225, v225
 v_rcp_f32 v226, v226
 v_rcp_f32 v227, v227
 v_mul_f32 v224, v24, v224
 v_mul_f32 v225, v25, v225
 v_mul_f32 v226, v26, v226
 v_mul_f32 v227, v27, v227
 v_cvt_pk_bf16_f32 v232, v224, v225
 v_cvt_pk_bf16_f32 v233, v226, v227
 v_mul_f32 v224, v176, v20
 v_mul_f32 v225, v176, v21
 v_mul_f32 v226, v176, v22
 v_mul_f32 v227, v176, v23
 v_exp_f32 v224, v224
 v_exp_f32 v225, v225
 v_exp_f32 v226, v226
 v_exp_f32 v227, v227
 v_add_f32 v224, 1.0, v224
 v_add_f32 v225, 1.0, v225
 v_add_f32 v226, 1.0, v226
 v_add_f32 v227, 1.0, v227
 v_rcp_f32 v224, v224
 v_rcp_f32 v225, v225
 v_rcp_f32 v226, v226
 v_rcp_f32 v227, v227
 v_mul_f32 v224, v28, v224
 v_mul_f32 v225, v29, v225
 v_mul_f32 v226, v30, v226
 v_mul_f32 v227, v31, v227
 v_cvt_pk_bf16_f32 v234, v224, v225
 v_cvt_pk_bf16_f32 v235, v226, v227
 s_add_u32 s41, s36, 6144
 buffer_store_dwordx4 v[232:235], v4, s[4:7], s41 offen sc1
 s_waitcnt vmcnt(0)
 s_barrier
 s_cmp_lg_u32 s20, 0
 s_cbranch_scc1 AR47
 s_lshl_b32 s58, s28, 4
 s_add_u32 s58, s58, s29
 s_lshl_b32 s58, s58, 7
 s_add_u32 s58, s58, 0xfc0000
 v_mov_b32 v2, s60
 v_mov_b32 v3, 0
 s_mov_b64 exec, 1
 buffer_store_dword v2, v3, s[4:7], s58 offen sc1
 s_mov_b64 exec, -1
AR47:
 s_lshr_b32 s31, s26, 1
 s_mul_i32 s33, s26, 229376
 s_mul_i32 s34, s20, 28672
 s_add_u32 s33, s33, s34
 s_add_u32 s33, s33, 0x800000
 s_add_u32 s34, s33, 114688
 s_add_u32 s49, s47, 262144
 buffer_load_dwordx4 v[128:131], v4, s[4:7], s49 offen sc1
 buffer_load_dwordx4 v[132:135], v4, s[4:7], s49 offen offset:1024 sc1
 s_add_u32 s49, s47, 278528
 buffer_load_dwordx4 v[136:139], v4, s[4:7], s49 offen sc1
 buffer_load_dwordx4 v[140:143], v4, s[4:7], s49 offen offset:1024 sc1
 s_add_u32 s49, s47, 294912
 buffer_load_dwordx4 v[144:147], v4, s[4:7], s49 offen sc1
 buffer_load_dwordx4 v[148:151], v4, s[4:7], s49 offen offset:1024 sc1
 s_add_u32 s49, s47, 311296
 buffer_load_dwordx4 v[152:155], v4, s[4:7], s49 offen sc1
 buffer_load_dwordx4 v[156:159], v4, s[4:7], s49 offen offset:1024 sc1
 s_add_u32 s49, s47, 327680
 buffer_load_dwordx4 v[160:163], v4, s[4:7], s49 offen sc1
 buffer_load_dwordx4 v[164:167], v4, s[4:7], s49 offen offset:1024 sc1
 s_add_u32 s49, s47, 344064
 buffer_load_dwordx4 v[168:171], v4, s[4:7], s49 offen sc1
 buffer_load_dwordx4 v[172:175], v4, s[4:7], s49 offen offset:1024 sc1
 s_add_u32 s49, s47, 360448
 buffer_load_dwordx4 v[188:191], v4, s[4:7], s49 offen sc1
 buffer_load_dwordx4 v[192:195], v4, s[4:7], s49 offen offset:1024 sc1
 s_add_u32 s49, s47, 376832
 buffer_load_dwordx4 v[196:199], v4, s[4:7], s49 offen sc1
 buffer_load_dwordx4 v[200:203], v4, s[4:7], s49 offen offset:1024 sc1
 s_add_u32 s49, s47, 393216
 buffer_load_dwordx4 v[204:207], v4, s[4:7], s49 offen sc1
 buffer_load_dwordx4 v[208:211], v4, s[4:7], s49 offen offset:1024 sc1
 s_add_u32 s49, s47, 409600
 buffer_load_dwordx4 v[212:215], v4, s[4:7], s49 offen sc1
 buffer_load_dwordx4 v[216:219], v4, s[4:7], s49 offen offset:1024 sc1
 s_add_u32 s49, s47, 425984
 buffer_load_dwordx4 v[220:223], v4, s[4:7], s49 offen sc1
 buffer_load_dwordx4 v[224:227], v4, s[4:7], s49 offen offset:1024 sc1
 s_add_u32 s49, s47, 442368
 buffer_load_dwordx4 v[228:231], v4, s[4:7], s49 offen sc1
 buffer_load_dwordx4 v[232:235], v4, s[4:7], s49 offen offset:1024 sc1
 s_cmp_lg_u32 s20, 0
 s_cbranch_scc1 PD51
BK48:
 s_lshl_b32 s58, s31, 11
 s_add_u32 s58, s58, 0xfc0000
 v_min_u32 v2, 15, v1
 v_lshlrev_b32 v2, 7, v2
 s_mov_b32 s59, 262144
PL50:
 buffer_load_dword v3, v2, s[4:7], s58 offen sc1
 s_waitcnt vmcnt(0)
 v_cmp_ne_u32 vcc, s60, v3
 s_cbranch_vccz PD51
 s_sleep 2
 s_sub_u32 s59, s59, 1
 s_cmp_lg_u32 s59, 0
 s_cbranch_scc1 PL50
PD51:
 s_barrier
 buffer_load_dwordx4 v[64:67], v4, s[4:7], s33 offen offset:0 sc1
 buffer_load_dwordx4 v[68:71], v4, s[4:7], s34 offen offset:0 sc1
 buffer_load_dwordx4 v[72:75], v4, s[4:7], s33 offen offset:1024 sc1
 buffer_load_dwordx4 v[76:79], v4, s[4:7], s34 offen offset:1024 sc1
 buffer_load_dwordx4 v[80:83], v4, s[4:7], s33 offen offset:2048 sc1
 buffer_load_dwordx4 v[84:87], v4, s[4:7], s34 offen offset:2048 sc1
 buffer_load_dwordx4 v[88:91], v4, s[4:7], s33 offen offset:3072 sc1
 buffer_load_dwordx4 v[92:95], v4, s[4:7], s34 offen offset:3072 sc1
 s_add_u32 s33, s33, 4096
 s_add_u32 s34, s34, 4096
 buffer_load_dwordx4 v[96:99], v4, s[4:7], s33 offen offset:0 sc1
 buffer_load_dwordx4 v[100:103], v4, s[4:7], s34 offen offset:0 sc1
 buffer_load_dwordx4 v[104:107], v4, s[4:7], s33 offen offset:1024 sc1
 buffer_load_dwordx4 v[108:111], v4, s[4:7], s34 offen offset:1024 sc1
 buffer_load_dwordx4 v[112:115], v4, s[4:7], s33 offen offset:2048 sc1
 buffer_load_dwordx4 v[116:119], v4, s[4:7], s34 offen offset:2048 sc1
 s_lshr_b32 s36, s20, 1
 s_lshl_b32 s35, s26, 1
 s_add_u32 s35, s35, s36
 s_lshl_b32 s35, s35, 7
 s_add_u32 s35, s35, 0xf10000
 v_and_b32 v9, 31, v1
 v_lshlrev_b32 v9, 2, v9
 buffer_load_dword v56, v9, s[4:7], s35 offen sc1
 s_waitcnt vmcnt(13)
 v_mfma_f32_32x32x16_bf16 a[0:15], a[128:131], v[64:67], 0
 buffer_load_dwordx4 v[120:123], v4, s[4:7], s33 offen offset:3072 sc1
 v_mfma_f32_32x32x16_bf16 a[16:31], a[128:131], v[68:71], 0
 buffer_load_dwordx4 v[124:127], v4, s[4:7], s34 offen offset:3072 sc1
 v_mfma_f32_32x32x16_bf16 a[32:47], a[132:135], v[64:67], 0
 v_mfma_f32_32x32x16_bf16 a[48:63], a[132:135], v[68:71], 0
 s_waitcnt vmcnt(13)
 v_mfma_f32_32x32x16_bf16 a[0:15], a[136:139], v[72:75], a[0:15]
 s_add_u32 s33, s33, 4096
 s_add_u32 s34, s34, 4096
 buffer_load_dwordx4 v[64:67], v4, s[4:7], s33 offen offset:0 sc1
 v_mfma_f32_32x32x16_bf16 a[16:31], a[136:139], v[76:79], a[16:31]
 buffer_load_dwordx4 v[68:71], v4, s[4:7], s34 offen offset:0 sc1
 v_mfma_f32_32x32x16_bf16 a[32:47], a[140:143], v[72:75], a[32:47]
 v_mfma_f32_32x32x16_bf16 a[48:63], a[140:143], v[76:79], a[48:63]
 s_waitcnt vmcnt(13)
 v_mfma_f32_32x32x16_bf16 a[0:15], a[144:147], v[80:83], a[0:15]
 buffer_load_dwordx4 v[72:75], v4, s[4:7], s33 offen offset:1024 sc1
 v_mfma_f32_32x32x16_bf16 a[16:31], a[144:147], v[84:87], a[16:31]
 buffer_load_dwordx4 v[76:79], v4, s[4:7], s34 offen offset:1024 sc1
 v_mfma_f32_32x32x16_bf16 a[32:47], a[148:151], v[80:83], a[32:47]
 v_mfma_f32_32x32x16_bf16 a[48:63], a[148:151], v[84:87], a[48:63]
 s_waitcnt vmcnt(13)
 v_mfma_f32_32x32x16_bf16 a[0:15], a[152:155], v[88:91], a[0:15]
 buffer_load_dwordx4 v[80:83], v4, s[4:7], s33 offen offset:2048 sc1
 v_mfma_f32_32x32x16_bf16 a[16:31], a[152:155], v[92:95], a[16:31]
 buffer_load_dwordx4 v[84:87], v4, s[4:7], s34 offen offset:2048 sc1
 v_mfma_f32_32x32x16_bf16 a[32:47], a[156:159], v[88:91], a[32:47]
 v_mfma_f32_32x32x16_bf16 a[48:63], a[156:159], v[92:95], a[48:63]
 s_waitcnt vmcnt(13)
 v_mfma_f32_32x32x16_bf16 a[0:15], a[160:163], v[96:99], a[0:15]
 buffer_load_dwordx4 v[88:91], v4, s[4:7], s33 offen offset:3072 sc1
 v_mfma_f32_32x32x16_bf16 a[16:31], a[160:163], v[100:103], a[16:31]
 buffer_load_dwordx4 v[92:95], v4, s[4:7], s34 offen offset:3072 sc1
 v_mfma_f32_32x32x16_bf16 a[32:47], a[164:167], v[96:99], a[32:47]
 v_mfma_f32_32x32x16_bf16 a[48:63], a[164:167], v[100:103], a[48:63]
 s_waitcnt vmcnt(13)
 v_mfma_f32_32x32x16_bf16 a[0:15], a[168:171], v[104:107], a[0:15]
 s_add_u32 s33, s33, 4096
 s_add_u32 s34, s34, 4096
 buffer_load_dwordx4 v[96:99], v4, s[4:7], s33 offen offset:0 sc1
 v_mfma_f32_32x32x16_bf16 a[16:31], a[168:171], v[108:111], a[16:31]
 buffer_load_dwordx4 v[100:103], v4, s[4:7], s34 offen offset:0 sc1
 v_mfma_f32_32x32x16_bf16 a[32:47], a[172:175], v[104:107], a[32:47]
 v_mfma_f32_32x32x16_bf16 a[48:63], a[172:175], v[108:111], a[48:63]
 s_waitcnt vmcnt(13)
 v_mfma_f32_32x32x16_bf16 a[0:15], a[176:179], v[112:115], a[0:15]
 buffer_load_dwordx4 v[104:107], v4, s[4:7], s33 offen offset:1024 sc1
 v_mfma_f32_32x32x16_bf16 a[16:31], a[176:179], v[116:119], a[16:31]
 buffer_load_dwordx4 v[108:111], v4, s[4:7], s34 offen offset:1024 sc1
 v_mfma_f32_32x32x16_bf16 a[32:47], a[180:183], v[112:115], a[32:47]
 v_mfma_f32_32x32x16_bf16 a[48:63], a[180:183], v[116:119], a[48:63]
 s_waitcnt vmcnt(12)
 v_mfma_f32_32x32x16_bf16 a[0:15], a[184:187], v[120:123], a[0:15]
 buffer_load_dwordx4 v[112:115], v4, s[4:7], s33 offen offset:2048 sc1
 v_mfma_f32_32x32x16_bf16 a[16:31], a[184:187], v[124:127], a[16:31]
 buffer_load_dwordx4 v[116:119], v4, s[4:7], s34 offen offset:2048 sc1
 v_mfma_f32_32x32x16_bf16 a[32:47], a[188:191], v[120:123], a[32:47]
 v_mfma_f32_32x32x16_bf16 a[48:63], a[188:191], v[124:127], a[48:63]
 s_waitcnt vmcnt(12)
 v_mfma_f32_32x32x16_bf16 a[0:15], a[192:195], v[64:67], a[0:15]
 buffer_load_dwordx4 v[120:123], v4, s[4:7], s33 offen offset:3072 sc1
 v_mfma_f32_32x32x16_bf16 a[16:31], a[192:195], v[68:71], a[16:31]
 buffer_load_dwordx4 v[124:127], v4, s[4:7], s34 offen offset:3072 sc1
 v_mfma_f32_32x32x16_bf16 a[32:47], a[196:199], v[64:67], a[32:47]
 v_mfma_f32_32x32x16_bf16 a[48:63], a[196:199], v[68:71], a[48:63]
 s_waitcnt vmcnt(12)
 v_mfma_f32_32x32x16_bf16 a[0:15], a[200:203], v[72:75], a[0:15]
 s_add_u32 s33, s33, 4096
 s_add_u32 s34, s34, 4096
 buffer_load_dwordx4 v[64:67], v4, s[4:7], s33 offen offset:0 sc1
 v_mfma_f32_32x32x16_bf16 a[16:31], a[200:203], v[76:79], a[16:31]
 buffer_load_dwordx4 v[68:71], v4, s[4:7], s34 offen offset:0 sc1
 v_mfma_f32_32x32x16_bf16 a[32:47], a[204:207], v[72:75], a[32:47]
 v_mfma_f32_32x32x16_bf16 a[48:63], a[204:207], v[76:79], a[48:63]
 s_waitcnt vmcnt(12)
 v_mfma_f32_32x32x16_bf16 a[0:15], a[208:211], v[80:83], a[0:15]
 buffer_load_dwordx4 v[72:75], v4, s[4:7], s33 offen offset:1024 sc1
 v_mfma_f32_32x32x16_bf16 a[16:31], a[208:211], v[84:87], a[16:31]
 buffer_load_dwordx4 v[76:79], v4, s[4:7], s34 offen offset:1024 sc1
 v_mfma_f32_32x32x16_bf16 a[32:47], a[212:215], v[80:83], a[32:47]
 v_mfma_f32_32x32x16_bf16 a[48:63], a[212:215], v[84:87], a[48:63]
 s_waitcnt vmcnt(12)
 v_mfma_f32_32x32x16_bf16 a[0:15], a[216:219], v[88:91], a[0:15]
 buffer_load_dwordx4 v[80:83], v4, s[4:7], s33 offen offset:2048 sc1
 v_mfma_f32_32x32x16_bf16 a[16:31], a[216:219], v[92:95], a[16:31]
 buffer_load_dwordx4 v[84:87], v4, s[4:7], s34 offen offset:2048 sc1
 v_mfma_f32_32x32x16_bf16 a[32:47], a[220:223], v[88:91], a[32:47]
 v_mfma_f32_32x32x16_bf16 a[48:63], a[220:223], v[92:95], a[48:63]
 s_waitcnt vmcnt(12)
 v_mfma_f32_32x32x16_bf16 a[0:15], a[224:227], v[96:99], a[0:15]
 buffer_load_dwordx4 v[88:91], v4, s[4:7], s33 offen offset:3072 sc1
 v_mfma_f32_32x32x16_bf16 a[16:31], a[224:227], v[100:103], a[16:31]
 buffer_load_dwordx4 v[92:95], v4, s[4:7], s34 offen offset:3072 sc1
 v_mfma_f32_32x32x16_bf16 a[32:47], a[228:231], v[96:99], a[32:47]
 v_mfma_f32_32x32x16_bf16 a[48:63], a[228:231], v[100:103], a[48:63]
 s_waitcnt vmcnt(12)
 v_mfma_f32_32x32x16_bf16 a[0:15], a[232:235], v[104:107], a[0:15]
 s_add_u32 s33, s33, 4096
 s_add_u32 s34, s34, 4096
 buffer_load_dwordx4 v[96:99], v4, s[4:7], s33 offen offset:0 sc1
 v_mfma_f32_32x32x16_bf16 a[16:31], a[232:235], v[108:111], a[16:31]
 buffer_load_dwordx4 v[100:103], v4, s[4:7], s34 offen offset:0 sc1
 v_mfma_f32_32x32x16_bf16 a[32:47], a[236:239], v[104:107], a[32:47]
 v_mfma_f32_32x32x16_bf16 a[48:63], a[236:239], v[108:111], a[48:63]
 s_waitcnt vmcnt(12)
 v_mfma_f32_32x32x16_bf16 a[0:15], a[240:243], v[112:115], a[0:15]
 buffer_load_dwordx4 v[104:107], v4, s[4:7], s33 offen offset:1024 sc1
 v_mfma_f32_32x32x16_bf16 a[16:31], a[240:243], v[116:119], a[16:31]
 buffer_load_dwordx4 v[108:111], v4, s[4:7], s34 offen offset:1024 sc1
 v_mfma_f32_32x32x16_bf16 a[32:47], a[244:247], v[112:115], a[32:47]
 v_mfma_f32_32x32x16_bf16 a[48:63], a[244:247], v[116:119], a[48:63]
 s_waitcnt vmcnt(12)
 v_mfma_f32_32x32x16_bf16 a[0:15], a[248:251], v[120:123], a[0:15]
 buffer_load_dwordx4 v[112:115], v4, s[4:7], s33 offen offset:2048 sc1
 v_mfma_f32_32x32x16_bf16 a[16:31], a[248:251], v[124:127], a[16:31]
 buffer_load_dwordx4 v[116:119], v4, s[4:7], s34 offen offset:2048 sc1
 v_mfma_f32_32x32x16_bf16 a[32:47], a[252:255], v[120:123], a[32:47]
 v_mfma_f32_32x32x16_bf16 a[48:63], a[252:255], v[124:127], a[48:63]
 s_waitcnt vmcnt(12)
 v_mfma_f32_32x32x16_bf16 a[0:15], v[128:131], v[64:67], a[0:15]
 buffer_load_dwordx4 v[120:123], v4, s[4:7], s33 offen offset:3072 sc1
 v_mfma_f32_32x32x16_bf16 a[16:31], v[128:131], v[68:71], a[16:31]
 buffer_load_dwordx4 v[124:127], v4, s[4:7], s34 offen offset:3072 sc1
 v_mfma_f32_32x32x16_bf16 a[32:47], v[132:135], v[64:67], a[32:47]
 v_mfma_f32_32x32x16_bf16 a[48:63], v[132:135], v[68:71], a[48:63]
 s_waitcnt vmcnt(12)
 v_mfma_f32_32x32x16_bf16 a[0:15], v[136:139], v[72:75], a[0:15]
 s_add_u32 s33, s33, 4096
 s_add_u32 s34, s34, 4096
 buffer_load_dwordx4 v[64:67], v4, s[4:7], s33 offen offset:0 sc1
 v_mfma_f32_32x32x16_bf16 a[16:31], v[136:139], v[76:79], a[16:31]
 buffer_load_dwordx4 v[68:71], v4, s[4:7], s34 offen offset:0 sc1
 v_mfma_f32_32x32x16_bf16 a[32:47], v[140:143], v[72:75], a[32:47]
 v_mfma_f32_32x32x16_bf16 a[48:63], v[140:143], v[76:79], a[48:63]
 s_waitcnt vmcnt(12)
 v_mfma_f32_32x32x16_bf16 a[0:15], v[144:147], v[80:83], a[0:15]
 buffer_load_dwordx4 v[72:75], v4, s[4:7], s33 offen offset:1024 sc1
 v_mfma_f32_32x32x16_bf16 a[16:31], v[144:147], v[84:87], a[16:31]
 buffer_load_dwordx4 v[76:79], v4, s[4:7], s34 offen offset:1024 sc1
 v_mfma_f32_32x32x16_bf16 a[32:47], v[148:151], v[80:83], a[32:47]
 v_mfma_f32_32x32x16_bf16 a[48:63], v[148:151], v[84:87], a[48:63]
 s_waitcnt vmcnt(12)
 v_mfma_f32_32x32x16_bf16 a[0:15], v[152:155], v[88:91], a[0:15]
 buffer_load_dwordx4 v[80:83], v4, s[4:7], s33 offen offset:2048 sc1
 v_mfma_f32_32x32x16_bf16 a[16:31], v[152:155], v[92:95], a[16:31]
 buffer_load_dwordx4 v[84:87], v4, s[4:7], s34 offen offset:2048 sc1
 v_mfma_f32_32x32x16_bf16 a[32:47], v[156:159], v[88:91], a[32:47]
 v_mfma_f32_32x32x16_bf16 a[48:63], v[156:159], v[92:95], a[48:63]
 s_waitcnt vmcnt(12)
 v_mfma_f32_32x32x16_bf16 a[0:15], v[160:163], v[96:99], a[0:15]
 buffer_load_dwordx4 v[88:91], v4, s[4:7], s33 offen offset:3072 sc1
 v_mfma_f32_32x32x16_bf16 a[16:31], v[160:163], v[100:103], a[16:31]
 buffer_load_dwordx4 v[92:95], v4, s[4:7], s34 offen offset:3072 sc1
 v_mfma_f32_32x32x16_bf16 a[32:47], v[164:167], v[96:99], a[32:47]
 v_mfma_f32_32x32x16_bf16 a[48:63], v[164:167], v[100:103], a[48:63]
 s_waitcnt vmcnt(12)
 v_mfma_f32_32x32x16_bf16 a[0:15], v[168:171], v[104:107], a[0:15]
 v_mfma_f32_32x32x16_bf16 a[16:31], v[168:171], v[108:111], a[16:31]
 v_mfma_f32_32x32x16_bf16 a[32:47], v[172:175], v[104:107], a[32:47]
 v_mfma_f32_32x32x16_bf16 a[48:63], v[172:175], v[108:111], a[48:63]
 s_waitcnt vmcnt(10)
 v_mfma_f32_32x32x16_bf16 a[0:15], v[188:191], v[112:115], a[0:15]
 v_mfma_f32_32x32x16_bf16 a[16:31], v[188:191], v[116:119], a[16:31]
 v_mfma_f32_32x32x16_bf16 a[32:47], v[192:195], v[112:115], a[32:47]
 v_mfma_f32_32x32x16_bf16 a[48:63], v[192:195], v[116:119], a[48:63]
 s_waitcnt vmcnt(8)
 v_mfma_f32_32x32x16_bf16 a[0:15], v[196:199], v[120:123], a[0:15]
 v_mfma_f32_32x32x16_bf16 a[16:31], v[196:199], v[124:127], a[16:31]
 v_mfma_f32_32x32x16_bf16 a[32:47], v[200:203], v[120:123], a[32:47]
 v_mfma_f32_32x32x16_bf16 a[48:63], v[200:203], v[124:127], a[48:63]
 s_waitcnt vmcnt(6)
 v_mfma_f32_32x32x16_bf16 a[0:15], v[204:207], v[64:67], a[0:15]
 v_mfma_f32_32x32x16_bf16 a[16:31], v[204:207], v[68:71], a[16:31]
 v_mfma_f32_32x32x16_bf16 a[32:47], v[208:211], v[64:67], a[32:47]
 v_mfma_f32_32x32x16_bf16 a[48:63], v[208:211], v[68:71], a[48:63]
 s_waitcnt vmcnt(4)
 v_mfma_f32_32x32x16_bf16 a[0:15], v[212:215], v[72:75], a[0:15]
 v_mfma_f32_32x32x16_bf16 a[16:31], v[212:215], v[76:79], a[16:31]
 v_mfma_f32_32x32x16_bf16 a[32:47], v[216:219], v[72:75], a[32:47]
 v_mfma_f32_32x32x16_bf16 a[48:63], v[216:219], v[76:79], a[48:63]
 s_waitcnt vmcnt(2)
 v_mfma_f32_32x32x16_bf16 a[0:15], v[220:223], v[80:83], a[0:15]
 v_mfma_f32_32x32x16_bf16 a[16:31], v[220:223], v[84:87], a[16:31]
 v_mfma_f32_32x32x16_bf16 a[32:47], v[224:227], v[80:83], a[32:47]
 v_mfma_f32_32x32x16_bf16 a[48:63], v[224:227], v[84:87], a[48:63]
 s_waitcnt vmcnt(0)
 v_mfma_f32_32x32x16_bf16 a[0:15], v[228:231], v[88:91], a[0:15]
 v_mfma_f32_32x32x16_bf16 a[16:31], v[228:231], v[92:95], a[16:31]
 v_mfma_f32_32x32x16_bf16 a[32:47], v[232:235], v[88:91], a[32:47]
 v_mfma_f32_32x32x16_bf16 a[48:63], v[232:235], v[92:95], a[48:63]
 s_mul_i32 s40, s20, 17408
 s_add_u32 s40, s40, 0
 v_and_b32 v10, 31, v1
 v_mul_u32_u24 v10, 272, v10
 v_lshrrev_b32 v11, 5, v1
 v_lshlrev_b32 v11, 4, v11
 v_add_u32 v10, v10, v11
 v_add_u32 v10, s40, v10
 s_nop 0
 ds_write_b128 v10, a[0:3] offset:0
 ds_write_b128 v10, a[4:7] offset:32
 ds_write_b128 v10, a[8:11] offset:64
 ds_write_b128 v10, a[12:15] offset:96
 ds_write_b128 v10, a[16:19] offset:8704
 ds_write_b128 v10, a[20:23] offset:8736
 ds_write_b128 v10, a[24:27] offset:8768
 ds_write_b128 v10, a[28:31] offset:8800
 ds_write_b128 v10, a[32:35] offset:128
 ds_write_b128 v10, a[36:39] offset:160
 ds_write_b128 v10, a[40:43] offset:192
 ds_write_b128 v10, a[44:47] offset:224
 ds_write_b128 v10, a[48:51] offset:8832
 ds_write_b128 v10, a[52:55] offset:8864
 ds_write_b128 v10, a[56:59] offset:8896
 ds_write_b128 v10, a[60:63] offset:8928
 s_waitcnt lgkmcnt(0)
 s_barrier
 s_lshr_b32 s36, s20, 1
 s_and_b32 s37, s20, 1
 s_mul_i32 s38, s36, 8704
 s_lshl_b32 s39, s37, 7
 s_add_u32 s38, s38, s39
 v_and_b32 v10, 31, v1
 v_mul_u32_u24 v10, 272, v10
 v_lshrrev_b32 v11, 5, v1
 v_lshlrev_b32 v11, 4, v11
 v_add_u32 v10, v10, v11
 v_add_u32 v10, s38, v10
 ds_read_b128 v[64:67], v10 offset:0
 ds_read_b128 v[68:71], v10 offset:32
 ds_read_b128 v[72:75], v10 offset:64
 ds_read_b128 v[76:79], v10 offset:96
 ds_read_b128 v[80:83], v10 offset:17408
 ds_read_b128 v[84:87], v10 offset:17440
 ds_read_b128 v[88:91], v10 offset:17472
 ds_read_b128 v[92:95], v10 offset:17504
 ds_read_b128 v[96:99], v10 offset:34816
 ds_read_b128 v[100:103], v10 offset:34848
 ds_read_b128 v[104:107], v10 offset:34880
 ds_read_b128 v[108:111], v10 offset:34912
 ds_read_b128 v[112:115], v10 offset:52224
 ds_read_b128 v[116:119], v10 offset:52256
 ds_read_b128 v[120:123], v10 offset:52288
 ds_read_b128 v[124:127], v10 offset:52320
 v_and_b32 v9, 31, v1
 v_lshlrev_b32 v9, 10, v9
 v_lshrrev_b32 v12, 5, v1
 v_lshlrev_b32 v12, 4, v12
 v_add_u32 v9, v9, v12
 s_lshl_b32 s32, s26, 16
 s_lshl_b32 s33, s36, 15
 s_add_u32 s32, s32, s33
 s_lshl_b32 s33, s27, 7
 s_add_u32 s32, s32, s33
 s_lshl_b32 s33, s37, 6
 s_add_u32 s32, s32, s33
 s_mov_b32 s12, s80
 s_and_b32 s13, s81, 0xffff
 s_mov_b32 s14, 0x200000
 s_mov_b32 s15, 0x20000
 v_lshlrev_b32 v128, 16, v180
 v_and_b32 v129, 0xffff0000, v180
 v_lshlrev_b32 v130, 16, v181
 v_and_b32 v131, 0xffff0000, v181
 v_lshlrev_b32 v132, 16, v182
 v_and_b32 v133, 0xffff0000, v182
 v_lshlrev_b32 v134, 16, v183
 v_and_b32 v135, 0xffff0000, v183
 v_lshlrev_b32 v136, 16, v184
 v_and_b32 v137, 0xffff0000, v184
 v_lshlrev_b32 v138, 16, v185
 v_and_b32 v139, 0xffff0000, v185
 v_lshlrev_b32 v140, 16, v186
 v_and_b32 v141, 0xffff0000, v186
 v_lshlrev_b32 v142, 16, v187
 v_and_b32 v143, 0xffff0000, v187
 s_waitcnt lgkmcnt(8)
 v_pk_add_f32 v[64:65], v[64:65], v[80:81]
 v_pk_add_f32 v[66:67], v[66:67], v[82:83]
 v_pk_add_f32 v[68:69], v[68:69], v[84:85]
 v_pk_add_f32 v[70:71], v[70:71], v[86:87]
 v_pk_add_f32 v[72:73], v[72:73], v[88:89]
 v_pk_add_f32 v[74:75], v[74:75], v[90:91]
 v_pk_add_f32 v[76:77], v[76:77], v[92:93]
 v_pk_add_f32 v[78:79], v[78:79], v[94:95]
 s_waitcnt lgkmcnt(0)
 v_pk_add_f32 v[96:97], v[96:97], v[112:113]
 v_pk_add_f32 v[98:99], v[98:99], v[114:115]
 v_pk_add_f32 v[100:101], v[100:101], v[116:117]
 v_pk_add_f32 v[102:103], v[102:103], v[118:119]
 v_pk_add_f32 v[104:105], v[104:105], v[120:121]
 v_pk_add_f32 v[106:107], v[106:107], v[122:123]
 v_pk_add_f32 v[108:109], v[108:109], v[124:125]
 v_pk_add_f32 v[110:111], v[110:111], v[126:127]
 v_pk_add_f32 v[64:65], v[64:65], v[96:97]
 v_pk_add_f32 v[66:67], v[66:67], v[98:99]
 v_pk_add_f32 v[68:69], v[68:69], v[100:101]
 v_pk_add_f32 v[70:71], v[70:71], v[102:103]
 v_pk_add_f32 v[72:73], v[72:73], v[104:105]
 v_pk_add_f32 v[74:75], v[74:75], v[106:107]
 v_pk_add_f32 v[76:77], v[76:77], v[108:109]
 v_pk_add_f32 v[78:79], v[78:79], v[110:111]
 v_pk_fma_f32 v[64:65], v[64:65], v[56:57], v[128:129] op_sel_hi:[1,0,1]
 v_pk_fma_f32 v[66:67], v[66:67], v[56:57], v[130:131] op_sel_hi:[1,0,1]
 v_pk_fma_f32 v[68:69], v[68:69], v[56:57], v[132:133] op_sel_hi:[1,0,1]
 v_pk_fma_f32 v[70:71], v[70:71], v[56:57], v[134:135] op_sel_hi:[1,0,1]
 v_pk_fma_f32 v[72:73], v[72:73], v[56:57], v[136:137] op_sel_hi:[1,0,1]
 v_pk_fma_f32 v[74:75], v[74:75], v[56:57], v[138:139] op_sel_hi:[1,0,1]
 v_pk_fma_f32 v[76:77], v[76:77], v[56:57], v[140:141] op_sel_hi:[1,0,1]
 v_pk_fma_f32 v[78:79], v[78:79], v[56:57], v[142:143] op_sel_hi:[1,0,1]
 v_cvt_pk_bf16_f32 v160, v64, v65
 v_cvt_pk_bf16_f32 v161, v66, v67
 v_cvt_pk_bf16_f32 v162, v68, v69
 v_cvt_pk_bf16_f32 v163, v70, v71
 v_cvt_pk_bf16_f32 v164, v72, v73
 v_cvt_pk_bf16_f32 v165, v74, v75
 v_cvt_pk_bf16_f32 v166, v76, v77
 v_cvt_pk_bf16_f32 v167, v78, v79
 v_permlane32_swap_b32 v160, v162
 v_permlane32_swap_b32 v161, v163
 v_permlane32_swap_b32 v164, v166
 v_permlane32_swap_b32 v165, v167
 buffer_store_dwordx4 v[160:163], v9, s[12:15], s32 offen offset:0
 buffer_store_dwordx4 v[164:167], v9, s[12:15], s32 offen offset:32
L_end:
 s_endpgm
L_codeend:
.section .rodata,"a"
.p2align 6
.amdhsa_kernel sequential_preLN__linear_kernel_hedgehog__glu_gated_glu__prompt_kernel
  .amdhsa_next_free_vgpr 512
  .amdhsa_next_free_sgpr 100
  .amdhsa_accum_offset 256
  .amdhsa_group_segment_fixed_size 0
  .amdhsa_kernarg_size 88
  .amdhsa_user_sgpr_count 2
  .amdhsa_user_sgpr_kernarg_segment_ptr 1
  .amdhsa_system_sgpr_workgroup_id_x 1
  .amdhsa_float_denorm_mode_32 3
.end_amdhsa_kernel
```
